```python
import torch

def _softmax(x, axis=-1):
    return torch.softmax(x, dim=axis)

def _gelu(x):
    return torch.nn.functional.gelu(x, approximate='tanh')

def _silu(x):
    return torch.nn.functional.silu(x)

def _sigmoid(x):
    return torch.sigmoid(x)

def _layernorm(x, axis=-1, eps=1e-05):
    m = x.mean(dim=axis, keepdim=True)
    v = x.var(dim=axis, keepdim=True, unbiased=False)
    return (x - m) / torch.sqrt(v + eps)

def _scatter_add(tgt, idx, src, axis=0):
    return tgt.clone().index_add_(axis, idx, src)

def _segment_sum(src, seg, n):
    out = torch.zeros((n,) + src.shape[1:], dtype=src.dtype)
    return out.index_add_(0, seg, src)

def _pad(x, pw):
    flat = tuple((v for pair in reversed(pw) for v in pair))
    return torch.nn.functional.pad(x, flat)
kernel_name = 'standalone__molecular_angular_painn__graph'

def setup_inputs():

    _w = lambda a: (lambda t: t.to(torch.bfloat16) if t.is_floating_point() else t)(torch.as_tensor(a))
    N, deg, D = (10000, 32, 128)
    n_rbf = max(16, 4)
    E = N * deg
    cutoff = 5.0
    freqs = (torch.arange(1, n_rbf + 1) * torch.pi / cutoff).to(float)
    return {'sv': _w((lambda *s: torch.randn(*s, dtype=torch.bfloat16) * 0.4)(N, 4, D) * 0.3), 'pos': _w((lambda *s: torch.randn(*s, dtype=torch.bfloat16) * 1.6)(N, 3) * 1.2), 'src': _w((lambda lo, hi, *s: torch.randint(lo, hi, s))(0, N, E).to(torch.int64)), 'dst': _w((lambda lo, hi, *s: torch.randint(lo, hi, s))(0, N, E).to(torch.int64)), 'freqs': _w(freqs), 'w_phi1': _w((lambda *s: torch.randn(*s, dtype=torch.bfloat16) * 3.2)(D, D) / D ** 0.5), 'w_phi2': _w((lambda *s: torch.randn(*s, dtype=torch.bfloat16) * 1.6)(D, 3 * D) / D ** 0.5), 'w_rbf': _w((lambda *s: torch.randn(*s, dtype=torch.bfloat16) * 1.6)(n_rbf, 3 * D) / n_rbf ** 0.5)}

def reference(sv, pos, src, dst, freqs, w_phi1, w_phi2, w_rbf):
    N, _, D = sv.shape
    E = src.shape[0]
    PI, cutoff = (3.141592653589793, 5.0)
    s, v = (sv[:, 0, :].clone(), sv[:, 1:, :].clone())
    r_vec = pos[src] - pos[dst]
    d = torch.sqrt((r_vec * r_vec).sum(-1) + 1e-08)
    r_hat = r_vec / d[:, None]
    rbf = torch.sin(d[:, None] * freqs[None, :]) / d[:, None]
    fcut = 0.5 * (torch.cos(PI * d / cutoff) + 1.0)
    fcut = torch.where(d < cutoff, fcut, 0.0 * d)
    Wf = rbf @ w_rbf * fcut[:, None]
    phi = (_silu(s @ w_phi1) @ w_phi2)[src]
    m = phi * Wf
    m_s, m_vv, m_vr = (m[:, :D].clone(), m[:, D:2 * D].clone(), m[:, 2 * D:].clone())
    ds = _segment_sum(m_s, dst, N)
    dv_e = m_vv[:, None, :] * v[src] + m_vr[:, None, :] * r_hat[:, :, None]
    dv = _segment_sum(dv_e.reshape(E, 3 * D), dst, N).reshape(N, 3, D)
    return sv + torch.concatenate([ds[:, None, :], dv], axis=1)
```

```asm
; @launch kernel=painn_pre_kernel grid=(230,1,1) block=(1024,1,1) lds=163840
; @launch kernel=painn_main_kernel grid=(256,1,1) block=(1024,1,1) lds=163840
.amdgcn_target "amdgcn-amd-amdhsa--gfx950"
.text

.globl painn_pre_kernel
.p2align 8
.type painn_pre_kernel,@function
painn_pre_kernel:
    s_cmp_ge_u32 s2, 230
    s_cbranch_scc1 K1_END
    s_load_dwordx16 s[8:23], s[0:1], 0
    s_load_dwordx2 s[24:25], s[0:1], 80
    v_lshrrev_b32 v4, 6, v0
    v_and_b32 v1, 63, v0
    v_readfirstlane_b32 s26, v4
    v_lshrrev_b32 v2, 4, v1
    v_and_b32 v3, 15, v1
    s_mov_b32 s54, 0x05040100
    s_mov_b32 s55, 0x07060302
    s_cmp_ge_u32 s2, 221
    s_cbranch_scc1 K1_MISC
    s_cmp_lt_u32 s2, 64
    s_cbranch_scc1 K1_BIN
    s_and_b32 s27, s26, 3
    s_bfe_u32 s28, s26, 0x10002
    s_lshr_b32 s58, s26, 3
    s_sub_u32 s29, s2, 64
    s_lshl_b32 s29, s29, 2
    s_add_u32 s29, s29, s27
    s_lshl_b32 s30, s29, 4
    v_lshlrev_b32 v6, 4, v3
    v_lshl_add_u32 v9, v2, 2, s30
    s_sub_u32 s3, s2, 64
    s_lshl_b32 s3, s3, 4
    s_add_u32 s3, s3, s26
    s_lshl_b32 s3, s3, 12
    v_lshl_add_u32 v10, v2, 10, v6
    v_add_u32 v10, s3, v10
    v_lshrrev_b32 v11, 3, v3
    v_mul_u32_u24 v11, 0x1010, v11
    v_lshl_add_u32 v11, v2, 8, v11
    v_and_b32 v12, 7, v3
    v_lshl_add_u32 v11, v12, 5, v11
    s_mov_b32 s34, 10240000
    s_mov_b32 s35, 0x00020000
    s_cmp_lg_u32 s58, 0
    s_cbranch_scc1 K1_HELP
    s_lshl_b32 s31, s28, 3
    v_add_u32 v5, s31, v2
    v_xor_b32 v7, v5, v3
    v_add_u32 v5, s30, v5
    v_lshlrev_b32 v5, 10, v5
    v_lshl_add_u32 v5, v7, 4, v5
    v_xor_b32 v8, 64, v5
    v_add_u32 v8, 0x1000, v8
    s_lshl_b32 s56, s27, 12
    s_lshl_b32 s3, s28, 11
    s_add_u32 s56, s56, s3
    s_add_u32 s56, s56, 147456
    s_add_u32 s57, s56, 1024
    v_lshl_add_u32 v7, v2, 11, v6
    s_lshr_b32 s48, s26, 1
    s_lshl_b32 s48, s48, 13
    s_and_b32 s3, s26, 1
    s_lshl_b32 s4, s3, 10
    s_add_u32 s49, s48, s4
    s_lshl_b32 s3, s3, 3
    s_add_u32 s48, s48, s3
    v_add_u32 v12, s48, v11
    s_mov_b32 s38, 32768
    s_mov_b32 s39, 0x00020000
    s_mov_b32 m0, s56
    s_waitcnt lgkmcnt(0)
    s_mov_b32 s32, s8
    s_mov_b32 s33, s9
    s_mov_b32 s36, s18
    s_mov_b32 s37, s19
    buffer_load_dwordx4 v[32:35], v7, s[36:39], s49 offen offset:0
    buffer_load_dwordx4 v[36:39], v7, s[36:39], s49 offen offset:256
    buffer_load_dwordx4 v[40:43], v7, s[36:39], s49 offen offset:512
    buffer_load_dwordx4 v[44:47], v7, s[36:39], s49 offen offset:768
    buffer_load_dwordx4 v5, s[32:35], 0 offen  lds
    s_mov_b32 m0, s57
    s_nop 0
    buffer_load_dwordx4 v8, s[32:35], 0 offen  lds
    s_lshl_b32 s3, s27, 12
    s_add_u32 s4, s3, 147456
    v_xor_b32 v124, v2, v3
    v_lshlrev_b32 v124, 4, v124
    v_lshl_add_u32 v124, v3, 8, v124
    v_add_u32 v124, s4, v124
    v_xor_b32 v125, 64, v124
    v_xor_b32 v126, 0x80, v124
    v_xor_b32 v15, 0xc0, v124
    s_add_u32 s3, s3, 131072
    s_lshl_b32 s4, s28, 11
    s_add_u32 s3, s3, s4
    v_lshl_add_u32 v7, v2, 9, v6
    v_add_u32 v7, s3, v7
    v_mov_b32 v14, v12
    v_lshlrev_b32 v11, 4, v1
    s_mul_i32 s3, s28, 0x1010
    v_xor_b32 v4, s3, v11
    s_lshl_b32 s3, s27, 12
    s_add_u32 s3, s3, 131072
    v_add_u32 v5, s3, v11
    v_lshrrev_b32 v13, 3, v3
    s_mov_b32 s3, 2560000
    v_mul_lo_u32 v8, v13, s3
    v_and_b32 v12, 7, v3
    v_lshlrev_b32 v12, 4, v12
    v_lshl_add_u32 v12, v9, 8, v12
    s_mul_i32 s3, s28, 5120000
    s_lshl_b32 s4, s58, 7
    s_add_u32 s3, s3, s4
    v_add3_u32 v8, v8, v12, s3
    s_mul_i32 s3, s28, 1280000
    s_add_u32 s3, s3, 10240000
    v_lshl_add_u32 v9, v9, 7, v6
    v_add_u32 v9, s3, v9
    s_lshl_b32 s3, s58, 11
    s_add_u32 s4, s3, 32768
    v_add_u32 v12, s4, v4
    v_add_u32 v13, 0xc000, v12
    s_add_u32 s44, s24, 0
    s_addc_u32 s45, s25, 0
    s_mov_b32 s46, 12800000
    s_mov_b32 s47, 0x00020000
    s_waitcnt vmcnt(2)
    v_xor_b32 v11, 16, v14
    v_perm_b32 v48, v36, v32, s54
    v_perm_b32 v49, v44, v40, s54
    ds_write_b64 v14, v[48:49] offset:0
    v_perm_b32 v50, v36, v32, s55
    v_perm_b32 v51, v44, v40, s55
    ds_write_b64 v14, v[50:51] offset:1024
    v_perm_b32 v52, v37, v33, s54
    v_perm_b32 v53, v45, v41, s54
    ds_write_b64 v14, v[52:53] offset:2048
    v_perm_b32 v54, v37, v33, s55
    v_perm_b32 v55, v45, v41, s55
    ds_write_b64 v14, v[54:55] offset:3072
    v_perm_b32 v56, v38, v34, s54
    v_perm_b32 v57, v46, v42, s54
    ds_write_b64 v11, v[56:57] offset:0
    v_perm_b32 v58, v38, v34, s55
    v_perm_b32 v59, v46, v42, s55
    ds_write_b64 v11, v[58:59] offset:1024
    v_perm_b32 v60, v39, v35, s54
    v_perm_b32 v61, v47, v43, s54
    ds_write_b64 v11, v[60:61] offset:2048
    v_perm_b32 v62, v39, v35, s55
    v_perm_b32 v63, v47, v43, s55
    ds_write_b64 v11, v[62:63] offset:3072
    s_waitcnt vmcnt(0) lgkmcnt(0)
    s_barrier
    ds_read_b128 v[16:19], v124
    ds_read_b128 v[20:23], v125
    ds_read_b128 v[24:27], v126
    ds_read_b128 v[28:31], v15
    ds_read_b128 v[80:83], v4 offset:0
    ds_read_b128 v[84:87], v4 offset:1024
    ds_read_b128 v[88:91], v4 offset:2048
    ds_read_b128 v[92:95], v4 offset:3072
    ds_read_b128 v[96:99], v4 offset:8192
    ds_read_b128 v[100:103], v4 offset:9216
    ds_read_b128 v[104:107], v4 offset:10240
    ds_read_b128 v[108:111], v4 offset:11264
    s_waitcnt lgkmcnt(7)
    v_mfma_f32_16x16x32_bf16 v[64:67], v[80:83], v[16:19], 0
    ds_read_b128 v[80:83], v4 offset:16384
    s_waitcnt lgkmcnt(7)
    v_mfma_f32_16x16x32_bf16 v[68:71], v[84:87], v[16:19], 0
    ds_read_b128 v[84:87], v4 offset:17408
    s_waitcnt lgkmcnt(7)
    v_mfma_f32_16x16x32_bf16 v[72:75], v[88:91], v[16:19], 0
    ds_read_b128 v[88:91], v4 offset:18432
    s_waitcnt lgkmcnt(7)
    v_mfma_f32_16x16x32_bf16 v[76:79], v[92:95], v[16:19], 0
    ds_read_b128 v[92:95], v4 offset:19456
    s_waitcnt lgkmcnt(7)
    v_mfma_f32_16x16x32_bf16 v[64:67], v[96:99], v[20:23], v[64:67]
    ds_read_b128 v[96:99], v4 offset:24576
    s_waitcnt lgkmcnt(7)
    v_mfma_f32_16x16x32_bf16 v[68:71], v[100:103], v[20:23], v[68:71]
    ds_read_b128 v[100:103], v4 offset:25600
    s_waitcnt lgkmcnt(7)
    v_mfma_f32_16x16x32_bf16 v[72:75], v[104:107], v[20:23], v[72:75]
    ds_read_b128 v[104:107], v4 offset:26624
    s_waitcnt lgkmcnt(7)
    v_mfma_f32_16x16x32_bf16 v[76:79], v[108:111], v[20:23], v[76:79]
    ds_read_b128 v[108:111], v4 offset:27648
    s_waitcnt lgkmcnt(7)
    v_mfma_f32_16x16x32_bf16 v[64:67], v[80:83], v[24:27], v[64:67]
    s_waitcnt lgkmcnt(6)
    v_mfma_f32_16x16x32_bf16 v[68:71], v[84:87], v[24:27], v[68:71]
    s_waitcnt lgkmcnt(5)
    v_mfma_f32_16x16x32_bf16 v[72:75], v[88:91], v[24:27], v[72:75]
    s_waitcnt lgkmcnt(4)
    v_mfma_f32_16x16x32_bf16 v[76:79], v[92:95], v[24:27], v[76:79]
    s_waitcnt lgkmcnt(3)
    v_mfma_f32_16x16x32_bf16 v[64:67], v[96:99], v[28:31], v[64:67]
    s_waitcnt lgkmcnt(2)
    v_mfma_f32_16x16x32_bf16 v[68:71], v[100:103], v[28:31], v[68:71]
    s_waitcnt lgkmcnt(1)
    v_mfma_f32_16x16x32_bf16 v[72:75], v[104:107], v[28:31], v[72:75]
    s_waitcnt lgkmcnt(0)
    v_mfma_f32_16x16x32_bf16 v[76:79], v[108:111], v[28:31], v[76:79]
    buffer_load_dwordx4 v[112:115], v10, s[32:35], 0 offen offset:256
    buffer_load_dwordx4 v[116:119], v10, s[32:35], 0 offen offset:512
    buffer_load_dwordx4 v[120:123], v10, s[32:35], 0 offen offset:768
    s_nop 0
    v_cvt_pk_bf16_f32 v48, v64, v68
    v_lshlrev_b32 v64, 16, v48
    v_and_b32 v68, 0xffff0000, v48
    v_mul_f32 v49, 0xbfb8aa3b, v64
    v_mul_f32 v50, 0xbfb8aa3b, v68
    v_exp_f32 v49, v49
    v_exp_f32 v50, v50
    v_add_f32 v49, 1.0, v49
    v_add_f32 v50, 1.0, v50
    v_rcp_f32 v49, v49
    v_rcp_f32 v50, v50
    v_mul_f32 v49, v49, v64
    v_mul_f32 v50, v50, v68
    v_cvt_pk_bf16_f32 v32, v49, v50
    v_cvt_pk_bf16_f32 v48, v72, v76
    v_lshlrev_b32 v72, 16, v48
    v_and_b32 v76, 0xffff0000, v48
    v_mul_f32 v51, 0xbfb8aa3b, v72
    v_mul_f32 v52, 0xbfb8aa3b, v76
    v_exp_f32 v51, v51
    v_exp_f32 v52, v52
    v_add_f32 v51, 1.0, v51
    v_add_f32 v52, 1.0, v52
    v_rcp_f32 v51, v51
    v_rcp_f32 v52, v52
    v_mul_f32 v51, v51, v72
    v_mul_f32 v52, v52, v76
    v_cvt_pk_bf16_f32 v33, v51, v52
    v_cvt_pk_bf16_f32 v48, v65, v69
    v_lshlrev_b32 v65, 16, v48
    v_and_b32 v69, 0xffff0000, v48
    v_mul_f32 v49, 0xbfb8aa3b, v65
    v_mul_f32 v50, 0xbfb8aa3b, v69
    v_exp_f32 v49, v49
    v_exp_f32 v50, v50
    v_add_f32 v49, 1.0, v49
    v_add_f32 v50, 1.0, v50
    v_rcp_f32 v49, v49
    v_rcp_f32 v50, v50
    v_mul_f32 v49, v49, v65
    v_mul_f32 v50, v50, v69
    v_cvt_pk_bf16_f32 v34, v49, v50
    v_cvt_pk_bf16_f32 v48, v73, v77
    v_lshlrev_b32 v73, 16, v48
    v_and_b32 v77, 0xffff0000, v48
    v_mul_f32 v51, 0xbfb8aa3b, v73
    v_mul_f32 v52, 0xbfb8aa3b, v77
    v_exp_f32 v51, v51
    v_exp_f32 v52, v52
    v_add_f32 v51, 1.0, v51
    v_add_f32 v52, 1.0, v52
    v_rcp_f32 v51, v51
    v_rcp_f32 v52, v52
    v_mul_f32 v51, v51, v73
    v_mul_f32 v52, v52, v77
    v_cvt_pk_bf16_f32 v35, v51, v52
    ds_write_b128 v7, v[32:35] offset:0
    v_cvt_pk_bf16_f32 v48, v66, v70
    v_lshlrev_b32 v66, 16, v48
    v_and_b32 v70, 0xffff0000, v48
    v_mul_f32 v49, 0xbfb8aa3b, v66
    v_mul_f32 v50, 0xbfb8aa3b, v70
    v_exp_f32 v49, v49
    v_exp_f32 v50, v50
    v_add_f32 v49, 1.0, v49
    v_add_f32 v50, 1.0, v50
    v_rcp_f32 v49, v49
    v_rcp_f32 v50, v50
    v_mul_f32 v49, v49, v66
    v_mul_f32 v50, v50, v70
    v_cvt_pk_bf16_f32 v36, v49, v50
    v_cvt_pk_bf16_f32 v48, v74, v78
    v_lshlrev_b32 v74, 16, v48
    v_and_b32 v78, 0xffff0000, v48
    v_mul_f32 v51, 0xbfb8aa3b, v74
    v_mul_f32 v52, 0xbfb8aa3b, v78
    v_exp_f32 v51, v51
    v_exp_f32 v52, v52
    v_add_f32 v51, 1.0, v51
    v_add_f32 v52, 1.0, v52
    v_rcp_f32 v51, v51
    v_rcp_f32 v52, v52
    v_mul_f32 v51, v51, v74
    v_mul_f32 v52, v52, v78
    v_cvt_pk_bf16_f32 v37, v51, v52
    v_cvt_pk_bf16_f32 v48, v67, v71
    v_lshlrev_b32 v67, 16, v48
    v_and_b32 v71, 0xffff0000, v48
    v_mul_f32 v49, 0xbfb8aa3b, v67
    v_mul_f32 v50, 0xbfb8aa3b, v71
    v_exp_f32 v49, v49
    v_exp_f32 v50, v50
    v_add_f32 v49, 1.0, v49
    v_add_f32 v50, 1.0, v50
    v_rcp_f32 v49, v49
    v_rcp_f32 v50, v50
    v_mul_f32 v49, v49, v67
    v_mul_f32 v50, v50, v71
    v_cvt_pk_bf16_f32 v38, v49, v50
    v_cvt_pk_bf16_f32 v48, v75, v79
    v_lshlrev_b32 v75, 16, v48
    v_and_b32 v79, 0xffff0000, v48
    v_mul_f32 v51, 0xbfb8aa3b, v75
    v_mul_f32 v52, 0xbfb8aa3b, v79
    v_exp_f32 v51, v51
    v_exp_f32 v52, v52
    v_add_f32 v51, 1.0, v51
    v_add_f32 v52, 1.0, v52
    v_rcp_f32 v51, v51
    v_rcp_f32 v52, v52
    v_mul_f32 v51, v51, v75
    v_mul_f32 v52, v52, v79
    v_cvt_pk_bf16_f32 v39, v51, v52
    ds_write_b128 v7, v[36:39] offset:256
    s_branch K1_G2
K1_HELP:
    v_mul_u32_u24 v14, 6144, v2
    v_add_u32 v14, v14, v6
    s_mov_b32 s42, 98304
    s_mov_b32 s43, 0x00020000
    s_sub_u32 s7, s26, 8
    s_mul_i32 s3, s7, 3
    s_add_u32 s3, s3, 0
    s_lshr_b32 s4, s3, 1
    s_and_b32 s3, s3, 1
    s_mul_i32 s5, s4, 43
    s_lshr_b32 s5, s5, 7
    s_mul_i32 s6, s5, 3
    s_sub_u32 s6, s4, s6
    s_mul_i32 s5, s5, 24576
    s_lshl_b32 s6, s6, 8
    s_add_u32 s5, s5, s6
    s_mul_i32 s6, s3, 3072
    s_add_u32 s50, s5, s6
    s_lshl_b32 s4, s4, 13
    s_lshl_b32 s3, s3, 3
    s_add_u32 s4, s4, s3
    s_add_u32 s4, s4, 32768
    v_add_u32 v124, s4, v11
    s_mul_i32 s3, s7, 3
    s_add_u32 s3, s3, 1
    s_lshr_b32 s4, s3, 1
    s_and_b32 s3, s3, 1
    s_mul_i32 s5, s4, 43
    s_lshr_b32 s5, s5, 7
    s_mul_i32 s6, s5, 3
    s_sub_u32 s6, s4, s6
    s_mul_i32 s5, s5, 24576
    s_lshl_b32 s6, s6, 8
    s_add_u32 s5, s5, s6
    s_mul_i32 s6, s3, 3072
    s_add_u32 s51, s5, s6
    s_lshl_b32 s4, s4, 13
    s_lshl_b32 s3, s3, 3
    s_add_u32 s4, s4, s3
    s_add_u32 s4, s4, 32768
    v_add_u32 v125, s4, v11
    s_mul_i32 s3, s7, 3
    s_add_u32 s3, s3, 2
    s_lshr_b32 s4, s3, 1
    s_and_b32 s3, s3, 1
    s_mul_i32 s5, s4, 43
    s_lshr_b32 s5, s5, 7
    s_mul_i32 s6, s5, 3
    s_sub_u32 s6, s4, s6
    s_mul_i32 s5, s5, 24576
    s_lshl_b32 s6, s6, 8
    s_add_u32 s5, s5, s6
    s_mul_i32 s6, s3, 3072
    s_add_u32 s52, s5, s6
    s_lshl_b32 s4, s4, 13
    s_lshl_b32 s3, s3, 3
    s_add_u32 s4, s4, s3
    s_add_u32 s4, s4, 32768
    v_add_u32 v126, s4, v11
    s_waitcnt lgkmcnt(0)
    s_mov_b32 s32, s8
    s_mov_b32 s33, s9
    s_mov_b32 s40, s20
    s_mov_b32 s41, s21
    buffer_load_dwordx4 v[32:35], v14, s[40:43], s50 offen offset:0
    buffer_load_dwordx4 v[36:39], v14, s[40:43], s50 offen offset:768
    buffer_load_dwordx4 v[40:43], v14, s[40:43], s50 offen offset:1536
    buffer_load_dwordx4 v[44:47], v14, s[40:43], s50 offen offset:2304
    buffer_load_dwordx4 v[48:51], v14, s[40:43], s51 offen offset:0
    buffer_load_dwordx4 v[52:55], v14, s[40:43], s51 offen offset:768
    buffer_load_dwordx4 v[56:59], v14, s[40:43], s51 offen offset:1536
    buffer_load_dwordx4 v[60:63], v14, s[40:43], s51 offen offset:2304
    buffer_load_dwordx4 v[64:67], v14, s[40:43], s52 offen offset:0
    buffer_load_dwordx4 v[68:71], v14, s[40:43], s52 offen offset:768
    buffer_load_dwordx4 v[72:75], v14, s[40:43], s52 offen offset:1536
    buffer_load_dwordx4 v[76:79], v14, s[40:43], s52 offen offset:2304
    v_lshlrev_b32 v11, 4, v1
    s_mul_i32 s3, s28, 0x1010
    v_xor_b32 v4, s3, v11
    s_lshl_b32 s3, s27, 12
    s_add_u32 s3, s3, 131072
    v_add_u32 v5, s3, v11
    v_lshrrev_b32 v13, 3, v3
    s_mov_b32 s3, 2560000
    v_mul_lo_u32 v8, v13, s3
    v_and_b32 v12, 7, v3
    v_lshlrev_b32 v12, 4, v12
    v_lshl_add_u32 v12, v9, 8, v12
    s_mul_i32 s3, s28, 5120000
    s_lshl_b32 s4, s58, 7
    s_add_u32 s3, s3, s4
    v_add3_u32 v8, v8, v12, s3
    s_mul_i32 s3, s28, 1280000
    s_add_u32 s3, s3, 10240000
    v_lshl_add_u32 v9, v9, 7, v6
    v_add_u32 v9, s3, v9
    s_lshl_b32 s3, s58, 11
    s_add_u32 s4, s3, 32768
    v_add_u32 v12, s4, v4
    v_add_u32 v13, 0xc000, v12
    s_add_u32 s44, s24, 0
    s_addc_u32 s45, s25, 0
    s_mov_b32 s46, 12800000
    s_mov_b32 s47, 0x00020000
    s_barrier
    buffer_load_dwordx4 v[112:115], v10, s[32:35], 0 offen offset:256
    buffer_load_dwordx4 v[116:119], v10, s[32:35], 0 offen offset:512
    buffer_load_dwordx4 v[120:123], v10, s[32:35], 0 offen offset:768
    s_waitcnt vmcnt(11)
    v_xor_b32 v15, 16, v124
    v_perm_b32 v80, v36, v32, s54
    v_perm_b32 v81, v44, v40, s54
    ds_write_b64 v124, v[80:81] offset:0
    v_perm_b32 v82, v36, v32, s55
    v_perm_b32 v83, v44, v40, s55
    ds_write_b64 v124, v[82:83] offset:1024
    v_perm_b32 v84, v37, v33, s54
    v_perm_b32 v85, v45, v41, s54
    ds_write_b64 v124, v[84:85] offset:2048
    v_perm_b32 v86, v37, v33, s55
    v_perm_b32 v87, v45, v41, s55
    ds_write_b64 v124, v[86:87] offset:3072
    v_perm_b32 v88, v38, v34, s54
    v_perm_b32 v89, v46, v42, s54
    ds_write_b64 v15, v[88:89] offset:0
    v_perm_b32 v90, v38, v34, s55
    v_perm_b32 v91, v46, v42, s55
    ds_write_b64 v15, v[90:91] offset:1024
    v_perm_b32 v92, v39, v35, s54
    v_perm_b32 v93, v47, v43, s54
    ds_write_b64 v15, v[92:93] offset:2048
    v_perm_b32 v94, v39, v35, s55
    v_perm_b32 v95, v47, v43, s55
    ds_write_b64 v15, v[94:95] offset:3072
    s_waitcnt vmcnt(7)
    v_xor_b32 v15, 16, v125
    v_perm_b32 v96, v52, v48, s54
    v_perm_b32 v97, v60, v56, s54
    ds_write_b64 v125, v[96:97] offset:0
    v_perm_b32 v98, v52, v48, s55
    v_perm_b32 v99, v60, v56, s55
    ds_write_b64 v125, v[98:99] offset:1024
    v_perm_b32 v100, v53, v49, s54
    v_perm_b32 v101, v61, v57, s54
    ds_write_b64 v125, v[100:101] offset:2048
    v_perm_b32 v102, v53, v49, s55
    v_perm_b32 v103, v61, v57, s55
    ds_write_b64 v125, v[102:103] offset:3072
    v_perm_b32 v104, v54, v50, s54
    v_perm_b32 v105, v62, v58, s54
    ds_write_b64 v15, v[104:105] offset:0
    v_perm_b32 v106, v54, v50, s55
    v_perm_b32 v107, v62, v58, s55
    ds_write_b64 v15, v[106:107] offset:1024
    v_perm_b32 v108, v55, v51, s54
    v_perm_b32 v109, v63, v59, s54
    ds_write_b64 v15, v[108:109] offset:2048
    v_perm_b32 v110, v55, v51, s55
    v_perm_b32 v111, v63, v59, s55
    ds_write_b64 v15, v[110:111] offset:3072
    s_waitcnt vmcnt(3)
    v_xor_b32 v15, 16, v126
    v_perm_b32 v80, v68, v64, s54
    v_perm_b32 v81, v76, v72, s54
    ds_write_b64 v126, v[80:81] offset:0
    v_perm_b32 v82, v68, v64, s55
    v_perm_b32 v83, v76, v72, s55
    ds_write_b64 v126, v[82:83] offset:1024
    v_perm_b32 v84, v69, v65, s54
    v_perm_b32 v85, v77, v73, s54
    ds_write_b64 v126, v[84:85] offset:2048
    v_perm_b32 v86, v69, v65, s55
    v_perm_b32 v87, v77, v73, s55
    ds_write_b64 v126, v[86:87] offset:3072
    v_perm_b32 v88, v70, v66, s54
    v_perm_b32 v89, v78, v74, s54
    ds_write_b64 v15, v[88:89] offset:0
    v_perm_b32 v90, v70, v66, s55
    v_perm_b32 v91, v78, v74, s55
    ds_write_b64 v15, v[90:91] offset:1024
    v_perm_b32 v92, v71, v67, s54
    v_perm_b32 v93, v79, v75, s54
    ds_write_b64 v15, v[92:93] offset:2048
    v_perm_b32 v94, v71, v67, s55
    v_perm_b32 v95, v79, v75, s55
    ds_write_b64 v15, v[94:95] offset:3072
K1_G2:
    v_lshlrev_b32 v10, 4, v0
    v_add_u32 v14, 147456, v10
    s_lshl_b32 s3, s27, 12
    s_lshl_b32 s4, s28, 7
    s_add_u32 s3, s3, s4
    s_lshl_b32 s4, s58, 2
    s_add_u32 s3, s3, s4
    v_lshlrev_b32 v7, 3, v3
    v_lshl_add_u32 v7, v2, 10, v7
    v_add_u32 v7, s3, v7
    v_add_u32 v15, 147456, v7
    s_cmp_ge_u32 s29, 625
    s_cselect_b32 s46, 0, s46
    s_waitcnt lgkmcnt(0)
    s_barrier
    ds_read_b128 v[16:19], v5 offset:0
    ds_read_b128 v[20:23], v5 offset:1024
    ds_read_b128 v[24:27], v5 offset:2048
    ds_read_b128 v[28:31], v5 offset:3072
    s_cmp_lg_u32 s58, 0
    s_cbranch_scc1 K1_G2V
    ds_read_b128 v[80:83], v12 offset:0
    ds_read_b128 v[84:87], v12 offset:1024
    ds_read_b128 v[88:91], v12 offset:2048
    ds_read_b128 v[92:95], v12 offset:3072
    ds_read_b128 v[96:99], v12 offset:24576
    ds_read_b128 v[100:103], v12 offset:25600
    ds_read_b128 v[104:107], v12 offset:26624
    ds_read_b128 v[108:111], v12 offset:27648
    s_waitcnt lgkmcnt(7)
    v_mfma_f32_16x16x32_bf16 v[48:51], v[16:19], v[80:83], 0
    ds_read_b128 v[80:83], v13 offset:0
    s_waitcnt lgkmcnt(7)
    v_mfma_f32_16x16x32_bf16 v[52:55], v[16:19], v[84:87], 0
    ds_read_b128 v[84:87], v13 offset:1024
    s_waitcnt lgkmcnt(7)
    v_mfma_f32_16x16x32_bf16 v[56:59], v[16:19], v[88:91], 0
    ds_read_b128 v[88:91], v13 offset:2048
    s_waitcnt lgkmcnt(7)
    v_mfma_f32_16x16x32_bf16 v[60:63], v[16:19], v[92:95], 0
    ds_read_b128 v[92:95], v13 offset:3072
    s_waitcnt lgkmcnt(7)
    v_mfma_f32_16x16x32_bf16 v[48:51], v[20:23], v[96:99], v[48:51]
    ds_read_b128 v[96:99], v13 offset:24576
    s_waitcnt lgkmcnt(7)
    v_mfma_f32_16x16x32_bf16 v[52:55], v[20:23], v[100:103], v[52:55]
    ds_read_b128 v[100:103], v13 offset:25600
    s_waitcnt lgkmcnt(7)
    v_mfma_f32_16x16x32_bf16 v[56:59], v[20:23], v[104:107], v[56:59]
    ds_read_b128 v[104:107], v13 offset:26624
    s_waitcnt lgkmcnt(7)
    v_mfma_f32_16x16x32_bf16 v[60:63], v[20:23], v[108:111], v[60:63]
    ds_read_b128 v[108:111], v13 offset:27648
    s_waitcnt lgkmcnt(7)
    v_mfma_f32_16x16x32_bf16 v[48:51], v[24:27], v[80:83], v[48:51]
    s_waitcnt lgkmcnt(6)
    v_mfma_f32_16x16x32_bf16 v[52:55], v[24:27], v[84:87], v[52:55]
    s_waitcnt lgkmcnt(5)
    v_mfma_f32_16x16x32_bf16 v[56:59], v[24:27], v[88:91], v[56:59]
    s_waitcnt lgkmcnt(4)
    v_mfma_f32_16x16x32_bf16 v[60:63], v[24:27], v[92:95], v[60:63]
    s_waitcnt lgkmcnt(3)
    v_mfma_f32_16x16x32_bf16 v[48:51], v[28:31], v[96:99], v[48:51]
    s_waitcnt lgkmcnt(2)
    v_mfma_f32_16x16x32_bf16 v[52:55], v[28:31], v[100:103], v[52:55]
    s_waitcnt lgkmcnt(1)
    v_mfma_f32_16x16x32_bf16 v[56:59], v[28:31], v[104:107], v[56:59]
    s_waitcnt lgkmcnt(0)
    v_mfma_f32_16x16x32_bf16 v[60:63], v[28:31], v[108:111], v[60:63]
K1_G2V:
    ds_read_b128 v[80:83], v12 offset:8192
    ds_read_b128 v[84:87], v12 offset:9216
    ds_read_b128 v[88:91], v12 offset:16384
    ds_read_b128 v[92:95], v12 offset:17408
    ds_read_b128 v[96:99], v12 offset:32768
    ds_read_b128 v[100:103], v12 offset:33792
    ds_read_b128 v[104:107], v12 offset:40960
    ds_read_b128 v[108:111], v12 offset:41984
    s_waitcnt lgkmcnt(7)
    v_mfma_f32_16x16x32_bf16 v[32:35], v[16:19], v[80:83], 0
    ds_read_b128 v[80:83], v13 offset:8192
    s_waitcnt lgkmcnt(7)
    v_mfma_f32_16x16x32_bf16 v[36:39], v[16:19], v[84:87], 0
    ds_read_b128 v[84:87], v13 offset:9216
    s_waitcnt lgkmcnt(7)
    v_mfma_f32_16x16x32_bf16 v[40:43], v[16:19], v[88:91], 0
    ds_read_b128 v[88:91], v13 offset:16384
    s_waitcnt lgkmcnt(7)
    v_mfma_f32_16x16x32_bf16 v[44:47], v[16:19], v[92:95], 0
    ds_read_b128 v[92:95], v13 offset:17408
    s_waitcnt lgkmcnt(7)
    v_mfma_f32_16x16x32_bf16 v[32:35], v[20:23], v[96:99], v[32:35]
    ds_read_b128 v[96:99], v13 offset:32768
    s_waitcnt lgkmcnt(7)
    v_mfma_f32_16x16x32_bf16 v[36:39], v[20:23], v[100:103], v[36:39]
    ds_read_b128 v[100:103], v13 offset:33792
    s_waitcnt lgkmcnt(7)
    v_mfma_f32_16x16x32_bf16 v[40:43], v[20:23], v[104:107], v[40:43]
    ds_read_b128 v[104:107], v13 offset:40960
    s_waitcnt lgkmcnt(7)
    v_mfma_f32_16x16x32_bf16 v[44:47], v[20:23], v[108:111], v[44:47]
    ds_read_b128 v[108:111], v13 offset:41984
    s_waitcnt lgkmcnt(7)
    v_mfma_f32_16x16x32_bf16 v[32:35], v[24:27], v[80:83], v[32:35]
    s_waitcnt lgkmcnt(6)
    v_mfma_f32_16x16x32_bf16 v[36:39], v[24:27], v[84:87], v[36:39]
    s_waitcnt lgkmcnt(5)
    v_mfma_f32_16x16x32_bf16 v[40:43], v[24:27], v[88:91], v[40:43]
    s_waitcnt lgkmcnt(4)
    v_mfma_f32_16x16x32_bf16 v[44:47], v[24:27], v[92:95], v[44:47]
    s_waitcnt lgkmcnt(3)
    v_mfma_f32_16x16x32_bf16 v[32:35], v[28:31], v[96:99], v[32:35]
    s_waitcnt lgkmcnt(2)
    v_mfma_f32_16x16x32_bf16 v[36:39], v[28:31], v[100:103], v[36:39]
    s_waitcnt lgkmcnt(1)
    v_mfma_f32_16x16x32_bf16 v[40:43], v[28:31], v[104:107], v[40:43]
    s_waitcnt lgkmcnt(0)
    v_mfma_f32_16x16x32_bf16 v[44:47], v[28:31], v[108:111], v[44:47]
    s_waitcnt vmcnt(0)
    ds_write_b128 v10, v[112:115]
    ds_write_b128 v10, v[116:119] offset:16384
    ds_write_b128 v14, v[120:123]
    s_cmp_lg_u32 s58, 0
    s_cbranch_scc1 K1_EPIV
    v_add_f32 v48, 0x00800000, v48
    v_add_f32 v52, 0x00800000, v52
    v_add_f32 v56, 0x00800000, v56
    v_add_f32 v60, 0x00800000, v60
    v_add_u32 v48, 0x8000, v48
    v_add_u32 v52, 0x8000, v52
    v_add_u32 v56, 0x8000, v56
    v_add_u32 v60, 0x8000, v60
    v_sub_u32_sdwa v52, v52, v48 dst_sel:DWORD dst_unused:UNUSED_PAD src0_sel:DWORD src1_sel:WORD_1
    v_sub_u32_sdwa v56, v56, v52 dst_sel:DWORD dst_unused:UNUSED_PAD src0_sel:DWORD src1_sel:WORD_1
    v_sub_u32_sdwa v60, v60, v56 dst_sel:DWORD dst_unused:UNUSED_PAD src0_sel:DWORD src1_sel:WORD_1
    v_perm_b32 v64, v52, v48, s55
    v_perm_b32 v65, v60, v56, s55
    v_add_f32 v49, 0x00800000, v49
    v_add_f32 v53, 0x00800000, v53
    v_add_f32 v57, 0x00800000, v57
    v_add_f32 v61, 0x00800000, v61
    v_add_u32 v49, 0x8000, v49
    v_add_u32 v53, 0x8000, v53
    v_add_u32 v57, 0x8000, v57
    v_add_u32 v61, 0x8000, v61
    v_sub_u32_sdwa v53, v53, v49 dst_sel:DWORD dst_unused:UNUSED_PAD src0_sel:DWORD src1_sel:WORD_1
    v_sub_u32_sdwa v57, v57, v53 dst_sel:DWORD dst_unused:UNUSED_PAD src0_sel:DWORD src1_sel:WORD_1
    v_sub_u32_sdwa v61, v61, v57 dst_sel:DWORD dst_unused:UNUSED_PAD src0_sel:DWORD src1_sel:WORD_1
    v_perm_b32 v66, v53, v49, s55
    v_perm_b32 v67, v61, v57, s55
    v_mov_b32 v68, v64
    v_mov_b32 v69, v65
    v_mov_b32_dpp v64, v66 row_ror:8 row_mask:0xf bank_mask:0xc
    v_mov_b32_dpp v65, v67 row_ror:8 row_mask:0xf bank_mask:0xc
    v_mov_b32_dpp v66, v68 row_ror:8 row_mask:0xf bank_mask:0x3
    v_mov_b32_dpp v67, v69 row_ror:8 row_mask:0xf bank_mask:0x3
    buffer_store_dwordx4 v[64:67], v9, s[44:47], 0 offen offset:0 sc1
    v_add_f32 v50, 0x00800000, v50
    v_add_f32 v54, 0x00800000, v54
    v_add_f32 v58, 0x00800000, v58
    v_add_f32 v62, 0x00800000, v62
    v_add_u32 v50, 0x8000, v50
    v_add_u32 v54, 0x8000, v54
    v_add_u32 v58, 0x8000, v58
    v_add_u32 v62, 0x8000, v62
    v_sub_u32_sdwa v54, v54, v50 dst_sel:DWORD dst_unused:UNUSED_PAD src0_sel:DWORD src1_sel:WORD_1
    v_sub_u32_sdwa v58, v58, v54 dst_sel:DWORD dst_unused:UNUSED_PAD src0_sel:DWORD src1_sel:WORD_1
    v_sub_u32_sdwa v62, v62, v58 dst_sel:DWORD dst_unused:UNUSED_PAD src0_sel:DWORD src1_sel:WORD_1
    v_perm_b32 v72, v54, v50, s55
    v_perm_b32 v73, v62, v58, s55
    v_add_f32 v51, 0x00800000, v51
    v_add_f32 v55, 0x00800000, v55
    v_add_f32 v59, 0x00800000, v59
    v_add_f32 v63, 0x00800000, v63
    v_add_u32 v51, 0x8000, v51
    v_add_u32 v55, 0x8000, v55
    v_add_u32 v59, 0x8000, v59
    v_add_u32 v63, 0x8000, v63
    v_sub_u32_sdwa v55, v55, v51 dst_sel:DWORD dst_unused:UNUSED_PAD src0_sel:DWORD src1_sel:WORD_1
    v_sub_u32_sdwa v59, v59, v55 dst_sel:DWORD dst_unused:UNUSED_PAD src0_sel:DWORD src1_sel:WORD_1
    v_sub_u32_sdwa v63, v63, v59 dst_sel:DWORD dst_unused:UNUSED_PAD src0_sel:DWORD src1_sel:WORD_1
    v_perm_b32 v74, v55, v51, s55
    v_perm_b32 v75, v63, v59, s55
    v_mov_b32 v76, v72
    v_mov_b32 v77, v73
    v_mov_b32_dpp v72, v74 row_ror:8 row_mask:0xf bank_mask:0xc
    v_mov_b32_dpp v73, v75 row_ror:8 row_mask:0xf bank_mask:0xc
    v_mov_b32_dpp v74, v76 row_ror:8 row_mask:0xf bank_mask:0x3
    v_mov_b32_dpp v75, v77 row_ror:8 row_mask:0xf bank_mask:0x3
    buffer_store_dwordx4 v[72:75], v9, s[44:47], 0 offen offset:256 sc1
K1_EPIV:
K1_B3:
    s_waitcnt lgkmcnt(0)
    s_barrier
    ds_read2st64_b32 v[112:113], v7 offset0:0 offset1:64
    ds_read_b32 v114, v15 offset:0
    ds_read2st64_b32 v[116:117], v7 offset0:1 offset1:65
    ds_read_b32 v118, v15 offset:256
    ds_read2st64_b32 v[120:121], v7 offset0:2 offset1:66
    ds_read_b32 v122, v15 offset:512
    ds_read2st64_b32 v[124:125], v7 offset0:3 offset1:67
    ds_read_b32 v126, v15 offset:768
    s_waitcnt lgkmcnt(6)
    v_lshlrev_b32 v96, 16, v112
    v_and_b32 v97, 0xffff0000, v112
    v_lshlrev_b32 v98, 16, v113
    v_and_b32 v99, 0xffff0000, v113
    v_lshlrev_b32 v100, 16, v114
    v_and_b32 v101, 0xffff0000, v114
    v_fmaak_f32 v96, v96, v32, 0x00800000
    v_fmaak_f32 v97, v97, v36, 0x00800000
    v_fmaak_f32 v98, v98, v32, 0x00800000
    v_fmaak_f32 v99, v99, v36, 0x00800000
    v_fmaak_f32 v100, v100, v32, 0x00800000
    v_fmaak_f32 v101, v101, v36, 0x00800000
    v_add_f32 v40, 0x00800000, v40
    v_add_f32 v44, 0x00800000, v44
    v_add_u32 v96, 0x8000, v96
    v_add_u32 v97, 0x8000, v97
    v_add_u32 v98, 0x8000, v98
    v_add_u32 v99, 0x8000, v99
    v_sub_u32_sdwa v97, v97, v96 dst_sel:DWORD dst_unused:UNUSED_PAD src0_sel:DWORD src1_sel:WORD_1
    v_sub_u32_sdwa v98, v98, v97 dst_sel:DWORD dst_unused:UNUSED_PAD src0_sel:DWORD src1_sel:WORD_1
    v_sub_u32_sdwa v99, v99, v98 dst_sel:DWORD dst_unused:UNUSED_PAD src0_sel:DWORD src1_sel:WORD_1
    v_perm_b32 v80, v97, v96, s55
    v_perm_b32 v81, v99, v98, s55
    v_add_u32 v100, 0x8000, v100
    v_add_u32 v101, 0x8000, v101
    v_add_u32 v40, 0x8000, v40
    v_add_u32 v44, 0x8000, v44
    v_sub_u32_sdwa v101, v101, v100 dst_sel:DWORD dst_unused:UNUSED_PAD src0_sel:DWORD src1_sel:WORD_1
    v_sub_u32_sdwa v40, v40, v101 dst_sel:DWORD dst_unused:UNUSED_PAD src0_sel:DWORD src1_sel:WORD_1
    v_sub_u32_sdwa v44, v44, v40 dst_sel:DWORD dst_unused:UNUSED_PAD src0_sel:DWORD src1_sel:WORD_1
    v_perm_b32 v82, v101, v100, s55
    v_perm_b32 v83, v44, v40, s55
    buffer_store_dwordx4 v[80:83], v8, s[44:47], 0 offen offset:0 sc1
    s_waitcnt lgkmcnt(4)
    v_lshlrev_b32 v104, 16, v116
    v_and_b32 v105, 0xffff0000, v116
    v_lshlrev_b32 v106, 16, v117
    v_and_b32 v107, 0xffff0000, v117
    v_lshlrev_b32 v108, 16, v118
    v_and_b32 v109, 0xffff0000, v118
    v_fmaak_f32 v104, v104, v33, 0x00800000
    v_fmaak_f32 v105, v105, v37, 0x00800000
    v_fmaak_f32 v106, v106, v33, 0x00800000
    v_fmaak_f32 v107, v107, v37, 0x00800000
    v_fmaak_f32 v108, v108, v33, 0x00800000
    v_fmaak_f32 v109, v109, v37, 0x00800000
    v_add_f32 v41, 0x00800000, v41
    v_add_f32 v45, 0x00800000, v45
    v_add_u32 v104, 0x8000, v104
    v_add_u32 v105, 0x8000, v105
    v_add_u32 v106, 0x8000, v106
    v_add_u32 v107, 0x8000, v107
    v_sub_u32_sdwa v105, v105, v104 dst_sel:DWORD dst_unused:UNUSED_PAD src0_sel:DWORD src1_sel:WORD_1
    v_sub_u32_sdwa v106, v106, v105 dst_sel:DWORD dst_unused:UNUSED_PAD src0_sel:DWORD src1_sel:WORD_1
    v_sub_u32_sdwa v107, v107, v106 dst_sel:DWORD dst_unused:UNUSED_PAD src0_sel:DWORD src1_sel:WORD_1
    v_perm_b32 v84, v105, v104, s55
    v_perm_b32 v85, v107, v106, s55
    v_add_u32 v108, 0x8000, v108
    v_add_u32 v109, 0x8000, v109
    v_add_u32 v41, 0x8000, v41
    v_add_u32 v45, 0x8000, v45
    v_sub_u32_sdwa v109, v109, v108 dst_sel:DWORD dst_unused:UNUSED_PAD src0_sel:DWORD src1_sel:WORD_1
    v_sub_u32_sdwa v41, v41, v109 dst_sel:DWORD dst_unused:UNUSED_PAD src0_sel:DWORD src1_sel:WORD_1
    v_sub_u32_sdwa v45, v45, v41 dst_sel:DWORD dst_unused:UNUSED_PAD src0_sel:DWORD src1_sel:WORD_1
    v_perm_b32 v86, v109, v108, s55
    v_perm_b32 v87, v45, v41, s55
    buffer_store_dwordx4 v[84:87], v8, s[44:47], 0 offen offset:256 sc1
    s_waitcnt lgkmcnt(2)
    v_lshlrev_b32 v96, 16, v120
    v_and_b32 v97, 0xffff0000, v120
    v_lshlrev_b32 v98, 16, v121
    v_and_b32 v99, 0xffff0000, v121
    v_lshlrev_b32 v100, 16, v122
    v_and_b32 v101, 0xffff0000, v122
    v_fmaak_f32 v96, v96, v34, 0x00800000
    v_fmaak_f32 v97, v97, v38, 0x00800000
    v_fmaak_f32 v98, v98, v34, 0x00800000
    v_fmaak_f32 v99, v99, v38, 0x00800000
    v_fmaak_f32 v100, v100, v34, 0x00800000
    v_fmaak_f32 v101, v101, v38, 0x00800000
    v_add_f32 v42, 0x00800000, v42
    v_add_f32 v46, 0x00800000, v46
    v_add_u32 v96, 0x8000, v96
    v_add_u32 v97, 0x8000, v97
    v_add_u32 v98, 0x8000, v98
    v_add_u32 v99, 0x8000, v99
    v_sub_u32_sdwa v97, v97, v96 dst_sel:DWORD dst_unused:UNUSED_PAD src0_sel:DWORD src1_sel:WORD_1
    v_sub_u32_sdwa v98, v98, v97 dst_sel:DWORD dst_unused:UNUSED_PAD src0_sel:DWORD src1_sel:WORD_1
    v_sub_u32_sdwa v99, v99, v98 dst_sel:DWORD dst_unused:UNUSED_PAD src0_sel:DWORD src1_sel:WORD_1
    v_perm_b32 v88, v97, v96, s55
    v_perm_b32 v89, v99, v98, s55
    v_add_u32 v100, 0x8000, v100
    v_add_u32 v101, 0x8000, v101
    v_add_u32 v42, 0x8000, v42
    v_add_u32 v46, 0x8000, v46
    v_sub_u32_sdwa v101, v101, v100 dst_sel:DWORD dst_unused:UNUSED_PAD src0_sel:DWORD src1_sel:WORD_1
    v_sub_u32_sdwa v42, v42, v101 dst_sel:DWORD dst_unused:UNUSED_PAD src0_sel:DWORD src1_sel:WORD_1
    v_sub_u32_sdwa v46, v46, v42 dst_sel:DWORD dst_unused:UNUSED_PAD src0_sel:DWORD src1_sel:WORD_1
    v_perm_b32 v90, v101, v100, s55
    v_perm_b32 v91, v46, v42, s55
    buffer_store_dwordx4 v[88:91], v8, s[44:47], 0 offen offset:512 sc1
    s_waitcnt lgkmcnt(0)
    v_lshlrev_b32 v104, 16, v124
    v_and_b32 v105, 0xffff0000, v124
    v_lshlrev_b32 v106, 16, v125
    v_and_b32 v107, 0xffff0000, v125
    v_lshlrev_b32 v108, 16, v126
    v_and_b32 v109, 0xffff0000, v126
    v_fmaak_f32 v104, v104, v35, 0x00800000
    v_fmaak_f32 v105, v105, v39, 0x00800000
    v_fmaak_f32 v106, v106, v35, 0x00800000
    v_fmaak_f32 v107, v107, v39, 0x00800000
    v_fmaak_f32 v108, v108, v35, 0x00800000
    v_fmaak_f32 v109, v109, v39, 0x00800000
    v_add_f32 v43, 0x00800000, v43
    v_add_f32 v47, 0x00800000, v47
    v_add_u32 v104, 0x8000, v104
    v_add_u32 v105, 0x8000, v105
    v_add_u32 v106, 0x8000, v106
    v_add_u32 v107, 0x8000, v107
    v_sub_u32_sdwa v105, v105, v104 dst_sel:DWORD dst_unused:UNUSED_PAD src0_sel:DWORD src1_sel:WORD_1
    v_sub_u32_sdwa v106, v106, v105 dst_sel:DWORD dst_unused:UNUSED_PAD src0_sel:DWORD src1_sel:WORD_1
    v_sub_u32_sdwa v107, v107, v106 dst_sel:DWORD dst_unused:UNUSED_PAD src0_sel:DWORD src1_sel:WORD_1
    v_perm_b32 v92, v105, v104, s55
    v_perm_b32 v93, v107, v106, s55
    v_add_u32 v108, 0x8000, v108
    v_add_u32 v109, 0x8000, v109
    v_add_u32 v43, 0x8000, v43
    v_add_u32 v47, 0x8000, v47
    v_sub_u32_sdwa v109, v109, v108 dst_sel:DWORD dst_unused:UNUSED_PAD src0_sel:DWORD src1_sel:WORD_1
    v_sub_u32_sdwa v43, v43, v109 dst_sel:DWORD dst_unused:UNUSED_PAD src0_sel:DWORD src1_sel:WORD_1
    v_sub_u32_sdwa v47, v47, v43 dst_sel:DWORD dst_unused:UNUSED_PAD src0_sel:DWORD src1_sel:WORD_1
    v_perm_b32 v94, v109, v108, s55
    v_perm_b32 v95, v47, v43, s55
    buffer_store_dwordx4 v[92:95], v8, s[44:47], 0 offen offset:768 sc1
K1_GEMM_END:
    s_endpgm
K1_BIN:
    s_lshl_b32 s48, s2, 7
    v_lshrrev_b32 v4, 3, v0
    v_lshlrev_b32 v4, 13, v4
    v_and_b32 v5, 7, v0
    v_lshl_add_u32 v4, v5, 4, v4
    v_add_u32 v4, s48, v4
    v_lshrrev_b32 v5, 5, v0
    v_lshlrev_b32 v5, 13, v5
    v_and_b32 v6, 31, v0
    v_lshl_add_u32 v5, v6, 2, v5
    s_add_u32 s3, s48, 1048576
    v_add_u32 v5, s3, v5
    v_lshlrev_b32 v7, 4, v1
    v_mov_b32 v22, 0
    v_lshlrev_b32 v23, 2, v0
    v_cmp_gt_u32 vcc, 80, v0
    s_nop 0
    s_mov_b64 exec, vcc
    ds_write_b32 v23, v22 offset:60416
    s_mov_b64 exec, -1
    s_lshl_b32 s49, s26, 12
    s_mov_b32 m0, s49
    s_mov_b32 s30, 1280000
    s_mov_b32 s31, 0x00020000
    s_mov_b32 s34, 1280000
    s_mov_b32 s35, 0x00020000
    s_mov_b32 s38, 60000
    s_mov_b32 s39, 0x00020000
    s_waitcnt lgkmcnt(0)
    s_mov_b32 s28, s12
    s_mov_b32 s29, s13
    s_mov_b32 s32, s14
    s_mov_b32 s33, s15
    s_mov_b32 s36, s10
    s_mov_b32 s37, s11
    buffer_load_dwordx4 v[8:11], v4, s[28:31], 0 offen
    buffer_load_dwordx4 v[16:19], v4, s[32:35], 0 offen
    s_cmp_eq_u32 s26, 15
    s_cbranch_scc1 K1_BIN_POSDONE
    buffer_load_dwordx4 v7, s[36:39], s49 offen offset:0 lds
    buffer_load_dwordx4 v7, s[36:39], s49 offen offset:1024 lds
    buffer_load_dwordx4 v7, s[36:39], s49 offen offset:2048 lds
    s_cmp_eq_u32 s26, 14
    s_cbranch_scc1 K1_BIN_POSDONE
    buffer_load_dwordx4 v7, s[36:39], s49 offen offset:3072 lds
K1_BIN_POSDONE:
    buffer_load_dword v12, v5, s[28:31], 0 offen
    buffer_load_dword v20, v5, s[32:35], 0 offen
    v_cmp_gt_u32 vcc, 1280000, v5
    s_nop 0
    s_mov_b64 s[86:87], vcc
    s_mov_b64 s[84:85], -1
    s_movk_i32 s51, 6679
    s_mov_b64 s[90:91], 0
    v_mov_b32 v23, 1
    v_mov_b32 v93, 0xffff0000
    v_mov_b32 v100, 388
    v_mov_b32 v101, 61440
    s_add_u32 s40, s24, 12800000
    s_addc_u32 s41, s25, 0
    s_mov_b32 s42, 10334208
    s_mov_b32 s43, 0x00020000
    s_waitcnt vmcnt(2)
    s_barrier
    v_mul_u32_u24 v28, 6, v8
    v_mul_u32_u24 v29, 6, v16
    v_and_b32 v84, -4, v28
    v_and_b32 v85, -4, v29
    ds_read2_b32 v[24:25], v84 offset0:0 offset1:1
    ds_read2_b32 v[26:27], v85 offset0:0 offset1:1
    v_mul_u32_u24 v34, 6, v9
    v_mul_u32_u24 v35, 6, v17
    v_and_b32 v84, -4, v34
    v_and_b32 v85, -4, v35
    ds_read2_b32 v[30:31], v84 offset0:0 offset1:1
    ds_read2_b32 v[32:33], v85 offset0:0 offset1:1
    v_mul_u32_u24 v40, 6, v10
    v_mul_u32_u24 v41, 6, v18
    v_and_b32 v84, -4, v40
    v_and_b32 v85, -4, v41
    ds_read2_b32 v[36:37], v84 offset0:0 offset1:1
    ds_read2_b32 v[38:39], v85 offset0:0 offset1:1
    v_mul_u32_u24 v46, 6, v11
    v_mul_u32_u24 v47, 6, v19
    v_and_b32 v84, -4, v46
    v_and_b32 v85, -4, v47
    ds_read2_b32 v[42:43], v84 offset0:0 offset1:1
    ds_read2_b32 v[44:45], v85 offset0:0 offset1:1
    s_waitcnt lgkmcnt(4)
    v_alignbyte_b32 v24, v25, v24, v28
    v_alignbyte_b32 v26, v27, v26, v29
    v_alignbyte_b32 v25, v25, v25, v28
    v_alignbyte_b32 v27, v27, v27, v29
    v_lshlrev_b32 v86, 16, v24
    v_lshlrev_b32 v28, 16, v26
    v_and_b32 v87, v93, v24
    v_and_b32 v29, v93, v26
    v_lshlrev_b32 v88, 16, v25
    v_lshlrev_b32 v27, 16, v27
    v_sub_f32 v86, v86, v28
    v_sub_f32 v87, v87, v29
    v_sub_f32 v88, v88, v27
    v_alignbyte_b32 v30, v31, v30, v34
    v_alignbyte_b32 v32, v33, v32, v35
    v_alignbyte_b32 v31, v31, v31, v34
    v_alignbyte_b32 v33, v33, v33, v35
    v_lshlrev_b32 v89, 16, v30
    v_lshlrev_b32 v34, 16, v32
    v_and_b32 v90, v93, v30
    v_and_b32 v35, v93, v32
    v_lshlrev_b32 v91, 16, v31
    v_lshlrev_b32 v33, 16, v33
    v_sub_f32 v89, v89, v34
    v_sub_f32 v90, v90, v35
    v_sub_f32 v91, v91, v33
    v_cvt_pk_bf16_f32 v92, v86, v87
    v_lshlrev_b32 v86, 16, v92
    v_and_b32 v87, 0xffff0000, v92
    v_cvt_pk_bf16_f32 v92, v89, v90
    v_lshlrev_b32 v89, 16, v92
    v_and_b32 v90, 0xffff0000, v92
    v_cvt_pk_bf16_f32 v92, v88, v91
    v_lshlrev_b32 v88, 16, v92
    v_and_b32 v91, 0xffff0000, v92
    v_mul_f32 v94, v86, v86
    v_mul_f32 v95, v87, v87
    v_mul_f32 v96, v88, v88
    v_mul_f32 v97, v89, v89
    v_mul_f32 v98, v90, v90
    v_mul_f32 v99, v91, v91
    v_cvt_pk_bf16_f32 v92, v94, v95
    v_lshlrev_b32 v94, 16, v92
    v_and_b32 v95, 0xffff0000, v92
    v_cvt_pk_bf16_f32 v92, v97, v98
    v_lshlrev_b32 v97, 16, v92
    v_and_b32 v98, 0xffff0000, v92
    v_cvt_pk_bf16_f32 v92, v96, v99
    v_lshlrev_b32 v96, 16, v92
    v_and_b32 v99, 0xffff0000, v92
    v_add_f32 v94, v94, v95
    v_add_f32 v97, v97, v98
    v_add_f32 v94, v94, v96
    v_mul_u32_u24 v76, s51, v16
    v_add_f32 v97, v97, v99
    v_mul_u32_u24 v77, s51, v17
    v_cvt_pk_bf16_f32 v92, v94, v97
    v_lshlrev_b32 v94, 16, v92
    v_and_b32 v97, 0xffff0000, v92
    v_add_f32 v94, 0x322bcc77, v94
    v_lshrrev_b32 v76, 18, v76
    v_add_f32 v97, 0x322bcc77, v97
    v_lshrrev_b32 v77, 18, v77
    v_cvt_pk_bf16_f32 v92, v94, v97
    v_lshlrev_b32 v94, 16, v92
    v_and_b32 v97, 0xffff0000, v92
    v_sqrt_f32 v94, v94
    v_sqrt_f32 v97, v97
    v_and_b32 v76, -4, v76
    v_and_b32 v77, -4, v77
    v_cvt_pk_bf16_f32 v92, v94, v97
    v_lshlrev_b32 v94, 16, v92
    v_and_b32 v97, 0xffff0000, v92
    v_cmp_gt_f32 vcc, 0x409d0000, v94
    v_rcp_f32 v95, v94
    s_and_b64 s[60:61], vcc, s[84:85]
    v_cmp_gt_f32 vcc, 0x409d0000, v97
    v_rcp_f32 v98, v97
    s_and_b64 s[62:63], vcc, s[84:85]
    s_mov_b64 exec, s[60:61]
    ds_add_rtn_u32 v59, v76, v23 offset:60416
    s_mov_b64 exec, s[62:63]
    ds_add_rtn_u32 v63, v77, v23 offset:60416
    v_lshrrev_b32 v97, 11, v97
    v_sub_u32 v97, 529440, v97
    v_cmp_ne_u32 vcc, 63968, v97
    v_fmaak_f32 v89, v89, v98, 0x00800000
    v_fmaak_f32 v90, v90, v98, 0x00800000
    v_fmaak_f32 v91, v91, v98, 0x00800000
    v_cndmask_b32 v97, 32, v97, vcc
    v_sub_u32 v89, v89, v9
    v_sub_u32 v91, v91, v17
    v_sub_u32 v90, v90, v97
    v_add_u32 v89, 0x8000, v89
    v_add_u32 v90, 0x8000, v90
    v_add_u32 v91, 0x8000, v91
    v_cmp_lt_u32 vcc, 37951, v97
    v_and_or_b32 v60, v89, v93, v9
    v_and_or_b32 v61, v90, v93, v97
    v_and_or_b32 v62, v91, v93, v17
    s_or_b64 s[90:91], s[90:91], vcc
    s_mov_b64 exec, s[60:61]
    v_lshrrev_b32 v94, 11, v94
    v_sub_u32 v94, 529440, v94
    v_cmp_ne_u32 vcc, 63968, v94
    v_fmaak_f32 v86, v86, v95, 0x00800000
    v_fmaak_f32 v87, v87, v95, 0x00800000
    v_fmaak_f32 v88, v88, v95, 0x00800000
    v_cndmask_b32 v94, 32, v94, vcc
    v_sub_u32 v86, v86, v8
    v_sub_u32 v88, v88, v16
    v_sub_u32 v87, v87, v94
    v_add_u32 v86, 0x8000, v86
    v_add_u32 v87, 0x8000, v87
    v_add_u32 v88, 0x8000, v88
    v_cmp_lt_u32 vcc, 37951, v94
    v_and_or_b32 v56, v86, v93, v8
    v_and_or_b32 v57, v87, v93, v94
    v_and_or_b32 v58, v88, v93, v16
    s_or_b64 s[90:91], s[90:91], vcc
    s_mov_b64 exec, -1
    s_waitcnt vmcnt(0)
    v_mul_u32_u24 v52, 6, v12
    v_mul_u32_u24 v53, 6, v20
    v_and_b32 v84, -4, v52
    v_and_b32 v85, -4, v53
    ds_read2_b32 v[48:49], v84 offset0:0 offset1:1
    ds_read2_b32 v[50:51], v85 offset0:0 offset1:1
    s_waitcnt lgkmcnt(2)
    v_alignbyte_b32 v36, v37, v36, v40
    v_alignbyte_b32 v38, v39, v38, v41
    v_alignbyte_b32 v37, v37, v37, v40
    v_alignbyte_b32 v39, v39, v39, v41
    v_lshlrev_b32 v86, 16, v36
    v_lshlrev_b32 v40, 16, v38
    v_and_b32 v87, v93, v36
    v_and_b32 v41, v93, v38
    v_lshlrev_b32 v88, 16, v37
    v_lshlrev_b32 v39, 16, v39
    v_sub_f32 v86, v86, v40
    v_sub_f32 v87, v87, v41
    v_sub_f32 v88, v88, v39
    v_alignbyte_b32 v42, v43, v42, v46
    v_alignbyte_b32 v44, v45, v44, v47
    v_alignbyte_b32 v43, v43, v43, v46
    v_alignbyte_b32 v45, v45, v45, v47
    v_lshlrev_b32 v89, 16, v42
    v_lshlrev_b32 v46, 16, v44
    v_and_b32 v90, v93, v42
    v_and_b32 v47, v93, v44
    v_lshlrev_b32 v91, 16, v43
    v_lshlrev_b32 v45, 16, v45
    v_sub_f32 v89, v89, v46
    v_sub_f32 v90, v90, v47
    v_sub_f32 v91, v91, v45
    v_min_u32 v84, 0x80, v59
    v_mad_u32_u24 v85, v76, v100, v101
    v_mad_u32_u24 v84, v84, 12, v85
    s_mov_b64 exec, s[60:61]
    ds_write2_b32 v84, v56, v57 offset0:0 offset1:1
    ds_write_b32 v84, v58 offset:8
    s_mov_b64 exec, -1
    v_min_u32 v84, 0x80, v63
    v_mad_u32_u24 v85, v77, v100, v101
    v_mad_u32_u24 v84, v84, 12, v85
    s_mov_b64 exec, s[62:63]
    ds_write2_b32 v84, v60, v61 offset0:0 offset1:1
    ds_write_b32 v84, v62 offset:8
    s_mov_b64 exec, -1
    v_cvt_pk_bf16_f32 v92, v86, v87
    v_lshlrev_b32 v86, 16, v92
    v_and_b32 v87, 0xffff0000, v92
    v_cvt_pk_bf16_f32 v92, v89, v90
    v_lshlrev_b32 v89, 16, v92
    v_and_b32 v90, 0xffff0000, v92
    v_cvt_pk_bf16_f32 v92, v88, v91
    v_lshlrev_b32 v88, 16, v92
    v_and_b32 v91, 0xffff0000, v92
    v_mul_f32 v94, v86, v86
    v_mul_f32 v95, v87, v87
    v_mul_f32 v96, v88, v88
    v_mul_f32 v97, v89, v89
    v_mul_f32 v98, v90, v90
    v_mul_f32 v99, v91, v91
    v_cvt_pk_bf16_f32 v92, v94, v95
    v_lshlrev_b32 v94, 16, v92
    v_and_b32 v95, 0xffff0000, v92
    v_cvt_pk_bf16_f32 v92, v97, v98
    v_lshlrev_b32 v97, 16, v92
    v_and_b32 v98, 0xffff0000, v92
    v_cvt_pk_bf16_f32 v92, v96, v99
    v_lshlrev_b32 v96, 16, v92
    v_and_b32 v99, 0xffff0000, v92
    v_add_f32 v94, v94, v95
    v_add_f32 v97, v97, v98
    v_add_f32 v94, v94, v96
    v_mul_u32_u24 v78, s51, v18
    v_add_f32 v97, v97, v99
    v_mul_u32_u24 v79, s51, v19
    v_cvt_pk_bf16_f32 v92, v94, v97
    v_lshlrev_b32 v94, 16, v92
    v_and_b32 v97, 0xffff0000, v92
    v_add_f32 v94, 0x322bcc77, v94
    v_lshrrev_b32 v78, 18, v78
    v_add_f32 v97, 0x322bcc77, v97
    v_lshrrev_b32 v79, 18, v79
    v_cvt_pk_bf16_f32 v92, v94, v97
    v_lshlrev_b32 v94, 16, v92
    v_and_b32 v97, 0xffff0000, v92
    v_sqrt_f32 v94, v94
    v_sqrt_f32 v97, v97
    v_and_b32 v78, -4, v78
    v_and_b32 v79, -4, v79
    v_cvt_pk_bf16_f32 v92, v94, v97
    v_lshlrev_b32 v94, 16, v92
    v_and_b32 v97, 0xffff0000, v92
    v_cmp_gt_f32 vcc, 0x409d0000, v94
    v_rcp_f32 v95, v94
    s_and_b64 s[64:65], vcc, s[84:85]
    v_cmp_gt_f32 vcc, 0x409d0000, v97
    v_rcp_f32 v98, v97
    s_and_b64 s[66:67], vcc, s[84:85]
    s_mov_b64 exec, s[64:65]
    ds_add_rtn_u32 v67, v78, v23 offset:60416
    s_mov_b64 exec, s[66:67]
    ds_add_rtn_u32 v71, v79, v23 offset:60416
    v_lshrrev_b32 v97, 11, v97
    v_sub_u32 v97, 529440, v97
    v_cmp_ne_u32 vcc, 63968, v97
    v_fmaak_f32 v89, v89, v98, 0x00800000
    v_fmaak_f32 v90, v90, v98, 0x00800000
    v_fmaak_f32 v91, v91, v98, 0x00800000
    v_cndmask_b32 v97, 32, v97, vcc
    v_sub_u32 v89, v89, v11
    v_sub_u32 v91, v91, v19
    v_sub_u32 v90, v90, v97
    v_add_u32 v89, 0x8000, v89
    v_add_u32 v90, 0x8000, v90
    v_add_u32 v91, 0x8000, v91
    v_cmp_lt_u32 vcc, 37951, v97
    v_and_or_b32 v68, v89, v93, v11
    v_and_or_b32 v69, v90, v93, v97
    v_and_or_b32 v70, v91, v93, v19
    s_or_b64 s[90:91], s[90:91], vcc
    s_mov_b64 exec, s[64:65]
    v_lshrrev_b32 v94, 11, v94
    v_sub_u32 v94, 529440, v94
    v_cmp_ne_u32 vcc, 63968, v94
    v_fmaak_f32 v86, v86, v95, 0x00800000
    v_fmaak_f32 v87, v87, v95, 0x00800000
    v_fmaak_f32 v88, v88, v95, 0x00800000
    v_cndmask_b32 v94, 32, v94, vcc
    v_sub_u32 v86, v86, v10
    v_sub_u32 v88, v88, v18
    v_sub_u32 v87, v87, v94
    v_add_u32 v86, 0x8000, v86
    v_add_u32 v87, 0x8000, v87
    v_add_u32 v88, 0x8000, v88
    v_cmp_lt_u32 vcc, 37951, v94
    v_and_or_b32 v64, v86, v93, v10
    v_and_or_b32 v65, v87, v93, v94
    v_and_or_b32 v66, v88, v93, v18
    s_or_b64 s[90:91], s[90:91], vcc
    s_mov_b64 exec, -1
    s_waitcnt lgkmcnt(0)
    v_alignbyte_b32 v48, v49, v48, v52
    v_alignbyte_b32 v50, v51, v50, v53
    v_alignbyte_b32 v49, v49, v49, v52
    v_alignbyte_b32 v51, v51, v51, v53
    v_lshlrev_b32 v86, 16, v48
    v_lshlrev_b32 v52, 16, v50
    v_and_b32 v87, v93, v48
    v_and_b32 v53, v93, v50
    v_lshlrev_b32 v88, 16, v49
    v_lshlrev_b32 v51, 16, v51
    v_sub_f32 v86, v86, v52
    v_sub_f32 v87, v87, v53
    v_sub_f32 v88, v88, v51
    v_min_u32 v84, 0x80, v67
    v_mad_u32_u24 v85, v78, v100, v101
    v_mad_u32_u24 v84, v84, 12, v85
    s_mov_b64 exec, s[64:65]
    ds_write2_b32 v84, v64, v65 offset0:0 offset1:1
    ds_write_b32 v84, v66 offset:8
    s_mov_b64 exec, -1
    v_min_u32 v84, 0x80, v71
    v_mad_u32_u24 v85, v79, v100, v101
    v_mad_u32_u24 v84, v84, 12, v85
    s_mov_b64 exec, s[66:67]
    ds_write2_b32 v84, v68, v69 offset0:0 offset1:1
    ds_write_b32 v84, v70 offset:8
    s_mov_b64 exec, -1
    v_cvt_pk_bf16_f32 v92, v86, v87
    v_lshlrev_b32 v86, 16, v92
    v_and_b32 v87, 0xffff0000, v92
    v_cvt_pk_bf16_f32 v88, v88, v88
    v_and_b32 v88, 0xffff0000, v88
    v_mul_f32 v94, v86, v86
    v_mul_f32 v95, v87, v87
    v_mul_f32 v96, v88, v88
    v_cvt_pk_bf16_f32 v92, v94, v95
    v_lshlrev_b32 v94, 16, v92
    v_and_b32 v95, 0xffff0000, v92
    v_cvt_pk_bf16_f32 v96, v96, v96
    v_and_b32 v96, 0xffff0000, v96
    v_add_f32 v94, v94, v95
    v_add_f32 v94, v94, v96
    v_mul_u32_u24 v80, s51, v20
    v_cvt_pk_bf16_f32 v94, v94, v94
    v_and_b32 v94, 0xffff0000, v94
    v_add_f32 v94, 0x322bcc77, v94
    v_lshrrev_b32 v80, 18, v80
    v_cvt_pk_bf16_f32 v94, v94, v94
    v_and_b32 v94, 0xffff0000, v94
    v_sqrt_f32 v94, v94
    v_and_b32 v80, -4, v80
    v_cvt_pk_bf16_f32 v94, v94, v94
    v_and_b32 v94, 0xffff0000, v94
    v_cmp_gt_f32 vcc, 0x409d0000, v94
    v_rcp_f32 v95, v94
    s_and_b64 s[68:69], vcc, s[86:87]
    s_mov_b64 exec, s[68:69]
    ds_add_rtn_u32 v75, v80, v23 offset:60416
    v_lshrrev_b32 v94, 11, v94
    v_sub_u32 v94, 529440, v94
    v_cmp_ne_u32 vcc, 63968, v94
    v_fmaak_f32 v86, v86, v95, 0x00800000
    v_fmaak_f32 v87, v87, v95, 0x00800000
    v_fmaak_f32 v88, v88, v95, 0x00800000
    v_cndmask_b32 v94, 32, v94, vcc
    v_sub_u32 v86, v86, v12
    v_sub_u32 v88, v88, v20
    v_sub_u32 v87, v87, v94
    v_add_u32 v86, 0x8000, v86
    v_add_u32 v87, 0x8000, v87
    v_add_u32 v88, 0x8000, v88
    v_cmp_lt_u32 vcc, 37951, v94
    v_and_or_b32 v72, v86, v93, v12
    v_and_or_b32 v73, v87, v93, v94
    v_and_or_b32 v74, v88, v93, v20
    s_or_b64 s[90:91], s[90:91], vcc
    s_mov_b64 exec, -1
    s_waitcnt lgkmcnt(0)
    v_min_u32 v84, 0x80, v75
    v_mad_u32_u24 v85, v80, v100, v101
    v_mad_u32_u24 v84, v84, 12, v85
    s_mov_b64 exec, s[68:69]
    ds_write2_b32 v84, v72, v73 offset0:0 offset1:1
    ds_write_b32 v84, v74 offset:8
    s_mov_b64 exec, -1
    v_mov_b32 v4, 60672
    s_mov_b64 exec, s[90:91]
    ds_write_b32 v4, v23
    s_mov_b64 exec, -1
    v_lshlrev_b32 v6, 2, v1
    s_mul_i32 s3, s26, 6208
    s_add_u32 s3, s3, 61440
    v_add_u32 v5, s3, v7
    s_mul_i32 s51, s26, 393216
    s_mul_i32 s3, s2, 1536
    s_add_u32 s51, s51, s3
    s_add_u32 s51, s51, 110592
    s_waitcnt lgkmcnt(0)
    s_barrier
    ds_read_b32 v8, v6 offset:60416
    ds_read_b32 v22, v4
    s_mov_b32 exec_hi, 0xffff
    ds_read_b128 v[24:27], v5 offset:0
    ds_read_b128 v[28:31], v5 offset:1552
    ds_read_b128 v[32:35], v5 offset:3104
    ds_read_b128 v[36:39], v5 offset:4656
    s_waitcnt lgkmcnt(3)
    buffer_store_dwordx4 v[24:27], v7, s[40:43], s51 offen sc1
    s_add_u32 s51, s51, 98304
    s_waitcnt lgkmcnt(2)
    buffer_store_dwordx4 v[28:31], v7, s[40:43], s51 offen sc1
    s_add_u32 s51, s51, 98304
    s_waitcnt lgkmcnt(1)
    buffer_store_dwordx4 v[32:35], v7, s[40:43], s51 offen sc1
    s_add_u32 s51, s51, 98304
    s_waitcnt lgkmcnt(0)
    buffer_store_dwordx4 v[36:39], v7, s[40:43], s51 offen sc1
    s_add_u32 s51, s51, 98304
    s_mov_b64 exec, -1
    v_cmp_lt_u32 vcc, 64, v8
    s_lshl_b32 s3, s26, 2
    s_lshr_b64 s[56:57], vcc, s3
    s_and_b32 s56, s56, 15
    s_cbranch_scc0 K1_BIN_XD
    s_sub_u32 s51, s51, 393216
    s_mov_b32 exec_hi, 0xffff
    s_bitcmp1_b32 s56, 0
    s_cbranch_scc0 K1_BIN_X0
    ds_read_b128 v[40:43], v5 offset:768
    s_waitcnt lgkmcnt(0)
    buffer_store_dwordx4 v[40:43], v7, s[40:43], s51 offen offset:768 sc1
K1_BIN_X0:
    s_add_u32 s51, s51, 98304
    s_bitcmp1_b32 s56, 1
    s_cbranch_scc0 K1_BIN_X1
    ds_read_b128 v[44:47], v5 offset:2320
    s_waitcnt lgkmcnt(0)
    buffer_store_dwordx4 v[44:47], v7, s[40:43], s51 offen offset:768 sc1
K1_BIN_X1:
    s_add_u32 s51, s51, 98304
    s_bitcmp1_b32 s56, 2
    s_cbranch_scc0 K1_BIN_X2
    ds_read_b128 v[48:51], v5 offset:3872
    s_waitcnt lgkmcnt(0)
    buffer_store_dwordx4 v[48:51], v7, s[40:43], s51 offen offset:768 sc1
K1_BIN_X2:
    s_add_u32 s51, s51, 98304
    s_bitcmp1_b32 s56, 3
    s_cbranch_scc0 K1_BIN_X3
    ds_read_b128 v[52:55], v5 offset:5424
    s_waitcnt lgkmcnt(0)
    buffer_store_dwordx4 v[52:55], v7, s[40:43], s51 offen offset:768 sc1
K1_BIN_X3:
    s_add_u32 s51, s51, 98304
    s_mov_b64 exec, -1
K1_BIN_XD:
    v_cmp_lt_u32 vcc, 0x80, v8
    s_cbranch_vccz K1_BIN_CNT
    s_mul_i32 s51, s2, 61440
    s_add_u32 s51, s51, 6402048
    v_cmp_lt_u32 vcc, 0x7f, v59
    s_nop 0
    s_and_b64 exec, vcc, s[60:61]
    ds_add_rtn_u32 v84, v4, v23 offset:4
    s_waitcnt lgkmcnt(0)
    v_mul_u32_u24 v84, 12, v84
    buffer_store_dwordx3 v[56:58], v84, s[40:43], s51 offen
    s_mov_b64 exec, -1
    v_cmp_lt_u32 vcc, 0x7f, v63
    s_nop 0
    s_and_b64 exec, vcc, s[62:63]
    ds_add_rtn_u32 v84, v4, v23 offset:4
    s_waitcnt lgkmcnt(0)
    v_mul_u32_u24 v84, 12, v84
    buffer_store_dwordx3 v[60:62], v84, s[40:43], s51 offen
    s_mov_b64 exec, -1
    v_cmp_lt_u32 vcc, 0x7f, v67
    s_nop 0
    s_and_b64 exec, vcc, s[64:65]
    ds_add_rtn_u32 v84, v4, v23 offset:4
    s_waitcnt lgkmcnt(0)
    v_mul_u32_u24 v84, 12, v84
    buffer_store_dwordx3 v[64:66], v84, s[40:43], s51 offen
    s_mov_b64 exec, -1
    v_cmp_lt_u32 vcc, 0x7f, v71
    s_nop 0
    s_and_b64 exec, vcc, s[66:67]
    ds_add_rtn_u32 v84, v4, v23 offset:4
    s_waitcnt lgkmcnt(0)
    v_mul_u32_u24 v84, 12, v84
    buffer_store_dwordx3 v[68:70], v84, s[40:43], s51 offen
    s_mov_b64 exec, -1
    v_cmp_lt_u32 vcc, 0x7f, v75
    s_nop 0
    s_and_b64 exec, vcc, s[68:69]
    ds_add_rtn_u32 v84, v4, v23 offset:4
    s_waitcnt lgkmcnt(0)
    v_mul_u32_u24 v84, 12, v84
    buffer_store_dwordx3 v[72:74], v84, s[40:43], s51 offen
    s_mov_b64 exec, -1
    s_barrier
K1_BIN_CNT:
    s_cmp_lg_u32 s26, 15
    s_cbranch_scc1 K1_BIN_DONE
    ds_read_b32 v10, v4 offset:4
    s_lshl_b32 s50, s2, 8
    s_add_u32 s50, s50, 90112
    v_lshl_or_b32 v9, v22, 31, v8
    buffer_store_dword v9, v6, s[40:43], s50 offen
    s_mov_b64 exec, 1
    s_lshl_b32 s50, s2, 2
    s_add_u32 s50, s50, 106496
    s_waitcnt lgkmcnt(0)
    buffer_store_dword v10, v6, s[40:43], s50 offen
K1_BIN_DONE:
    s_endpgm
K1_MISC:
    s_cmp_gt_u32 s2, 229
    s_cbranch_scc1 K1_END
    s_cmp_ge_u32 s2, 229
    s_cbranch_scc1 K1_WRF
    s_cmp_ge_u32 s26, 4
    s_cbranch_scc1 K1_END
    s_sub_u32 s27, s2, 221
    s_lshl_b32 s27, s27, 8
    v_add_u32 v4, s27, v0
    v_sub_u32 v5, 16545, v4
    v_mov_b32 v6, 14546
    v_cmp_gt_u32 vcc, 2, v4
    s_nop 1
    v_cndmask_b32 v5, v5, v6, vcc
    s_waitcnt lgkmcnt(0)
    s_load_dwordx8 s[28:35], s[16:17], 0
    s_add_u32 s40, s24, 12800000
    s_addc_u32 s41, s25, 0
    s_mov_b32 s42, 64000
    s_mov_b32 s43, 0x00020000
    v_lshlrev_b32 v5, 16, v5
    v_rcp_f32 v6, v5
    v_mul_f32 v7, 0x40490fdb, v5
    v_cvt_pk_bf16_f32 v7, v7, v7
    v_and_b32 v7, 0xffff0000, v7
    v_mul_f32 v7, 0x3e4ccccd, v7
    v_cvt_pk_bf16_f32 v7, v7, v7
    v_and_b32 v7, 0xffff0000, v7
    v_mul_f32 v7, 0x3e22f983, v7
    v_cos_f32 v7, v7
    s_nop 0
    v_cvt_pk_bf16_f32 v7, v7, v7
    v_and_b32 v7, 0xffff0000, v7
    v_add_f32 v7, 1.0, v7
    v_cvt_pk_bf16_f32 v7, v7, v7
    v_and_b32 v7, 0xffff0000, v7
    v_mul_f32 v7, 0.5, v7
    v_cmp_ne_u32 vcc, 0, v4
    s_nop 1
    v_cndmask_b32 v7, 0, v7, vcc
    s_waitcnt lgkmcnt(0)
    s_lshl_b32 s36, s28, 16
    s_and_b32 s37, s28, 0xffff0000
    v_mul_f32 v8, s36, v5
    v_mul_f32 v9, s37, v5
    v_cvt_pk_bf16_f32 v10, v8, v9
    v_lshlrev_b32 v8, 16, v10
    v_and_b32 v9, 0xffff0000, v10
    v_mul_f32 v8, 0x3e22f983, v8
    v_mul_f32 v9, 0x3e22f983, v9
    v_rndne_f32 v10, v8
    v_rndne_f32 v11, v9
    v_sub_f32 v8, v8, v10
    v_sub_f32 v9, v9, v11
    v_sin_f32 v8, v8
    v_sin_f32 v9, v9
    s_nop 0
    v_cvt_pk_bf16_f32 v10, v8, v9
    v_lshlrev_b32 v8, 16, v10
    v_and_b32 v9, 0xffff0000, v10
    v_mul_f32 v8, v8, v6
    v_mul_f32 v9, v9, v6
    v_cvt_pk_bf16_f32 v10, v8, v9
    v_lshlrev_b32 v8, 16, v10
    v_and_b32 v9, 0xffff0000, v10
    v_mul_f32 v8, v8, v7
    v_mul_f32 v9, v9, v7
    v_cvt_pk_bf16_f32 v16, v8, v9
    s_lshl_b32 s36, s29, 16
    s_and_b32 s37, s29, 0xffff0000
    v_mul_f32 v8, s36, v5
    v_mul_f32 v9, s37, v5
    v_cvt_pk_bf16_f32 v10, v8, v9
    v_lshlrev_b32 v8, 16, v10
    v_and_b32 v9, 0xffff0000, v10
    v_mul_f32 v8, 0x3e22f983, v8
    v_mul_f32 v9, 0x3e22f983, v9
    v_rndne_f32 v10, v8
    v_rndne_f32 v11, v9
    v_sub_f32 v8, v8, v10
    v_sub_f32 v9, v9, v11
    v_sin_f32 v8, v8
    v_sin_f32 v9, v9
    s_nop 0
    v_cvt_pk_bf16_f32 v10, v8, v9
    v_lshlrev_b32 v8, 16, v10
    v_and_b32 v9, 0xffff0000, v10
    v_mul_f32 v8, v8, v6
    v_mul_f32 v9, v9, v6
    v_cvt_pk_bf16_f32 v10, v8, v9
    v_lshlrev_b32 v8, 16, v10
    v_and_b32 v9, 0xffff0000, v10
    v_mul_f32 v8, v8, v7
    v_mul_f32 v9, v9, v7
    v_cvt_pk_bf16_f32 v17, v8, v9
    s_lshl_b32 s36, s30, 16
    s_and_b32 s37, s30, 0xffff0000
    v_mul_f32 v8, s36, v5
    v_mul_f32 v9, s37, v5
    v_cvt_pk_bf16_f32 v10, v8, v9
    v_lshlrev_b32 v8, 16, v10
    v_and_b32 v9, 0xffff0000, v10
    v_mul_f32 v8, 0x3e22f983, v8
    v_mul_f32 v9, 0x3e22f983, v9
    v_rndne_f32 v10, v8
    v_rndne_f32 v11, v9
    v_sub_f32 v8, v8, v10
    v_sub_f32 v9, v9, v11
    v_sin_f32 v8, v8
    v_sin_f32 v9, v9
    s_nop 0
    v_cvt_pk_bf16_f32 v10, v8, v9
    v_lshlrev_b32 v8, 16, v10
    v_and_b32 v9, 0xffff0000, v10
    v_mul_f32 v8, v8, v6
    v_mul_f32 v9, v9, v6
    v_cvt_pk_bf16_f32 v10, v8, v9
    v_lshlrev_b32 v8, 16, v10
    v_and_b32 v9, 0xffff0000, v10
    v_mul_f32 v8, v8, v7
    v_mul_f32 v9, v9, v7
    v_cvt_pk_bf16_f32 v18, v8, v9
    s_lshl_b32 s36, s31, 16
    s_and_b32 s37, s31, 0xffff0000
    v_mul_f32 v8, s36, v5
    v_mul_f32 v9, s37, v5
    v_cvt_pk_bf16_f32 v10, v8, v9
    v_lshlrev_b32 v8, 16, v10
    v_and_b32 v9, 0xffff0000, v10
    v_mul_f32 v8, 0x3e22f983, v8
    v_mul_f32 v9, 0x3e22f983, v9
    v_rndne_f32 v10, v8
    v_rndne_f32 v11, v9
    v_sub_f32 v8, v8, v10
    v_sub_f32 v9, v9, v11
    v_sin_f32 v8, v8
    v_sin_f32 v9, v9
    s_nop 0
    v_cvt_pk_bf16_f32 v10, v8, v9
    v_lshlrev_b32 v8, 16, v10
    v_and_b32 v9, 0xffff0000, v10
    v_mul_f32 v8, v8, v6
    v_mul_f32 v9, v9, v6
    v_cvt_pk_bf16_f32 v10, v8, v9
    v_lshlrev_b32 v8, 16, v10
    v_and_b32 v9, 0xffff0000, v10
    v_mul_f32 v8, v8, v7
    v_mul_f32 v9, v9, v7
    v_cvt_pk_bf16_f32 v19, v8, v9
    s_lshl_b32 s36, s32, 16
    s_and_b32 s37, s32, 0xffff0000
    v_mul_f32 v8, s36, v5
    v_mul_f32 v9, s37, v5
    v_cvt_pk_bf16_f32 v10, v8, v9
    v_lshlrev_b32 v8, 16, v10
    v_and_b32 v9, 0xffff0000, v10
    v_mul_f32 v8, 0x3e22f983, v8
    v_mul_f32 v9, 0x3e22f983, v9
    v_rndne_f32 v10, v8
    v_rndne_f32 v11, v9
    v_sub_f32 v8, v8, v10
    v_sub_f32 v9, v9, v11
    v_sin_f32 v8, v8
    v_sin_f32 v9, v9
    s_nop 0
    v_cvt_pk_bf16_f32 v10, v8, v9
    v_lshlrev_b32 v8, 16, v10
    v_and_b32 v9, 0xffff0000, v10
    v_mul_f32 v8, v8, v6
    v_mul_f32 v9, v9, v6
    v_cvt_pk_bf16_f32 v10, v8, v9
    v_lshlrev_b32 v8, 16, v10
    v_and_b32 v9, 0xffff0000, v10
    v_mul_f32 v8, v8, v7
    v_mul_f32 v9, v9, v7
    v_cvt_pk_bf16_f32 v20, v8, v9
    s_lshl_b32 s36, s33, 16
    s_and_b32 s37, s33, 0xffff0000
    v_mul_f32 v8, s36, v5
    v_mul_f32 v9, s37, v5
    v_cvt_pk_bf16_f32 v10, v8, v9
    v_lshlrev_b32 v8, 16, v10
    v_and_b32 v9, 0xffff0000, v10
    v_mul_f32 v8, 0x3e22f983, v8
    v_mul_f32 v9, 0x3e22f983, v9
    v_rndne_f32 v10, v8
    v_rndne_f32 v11, v9
    v_sub_f32 v8, v8, v10
    v_sub_f32 v9, v9, v11
    v_sin_f32 v8, v8
    v_sin_f32 v9, v9
    s_nop 0
    v_cvt_pk_bf16_f32 v10, v8, v9
    v_lshlrev_b32 v8, 16, v10
    v_and_b32 v9, 0xffff0000, v10
    v_mul_f32 v8, v8, v6
    v_mul_f32 v9, v9, v6
    v_cvt_pk_bf16_f32 v10, v8, v9
    v_lshlrev_b32 v8, 16, v10
    v_and_b32 v9, 0xffff0000, v10
    v_mul_f32 v8, v8, v7
    v_mul_f32 v9, v9, v7
    v_cvt_pk_bf16_f32 v21, v8, v9
    s_lshl_b32 s36, s34, 16
    s_and_b32 s37, s34, 0xffff0000
    v_mul_f32 v8, s36, v5
    v_mul_f32 v9, s37, v5
    v_cvt_pk_bf16_f32 v10, v8, v9
    v_lshlrev_b32 v8, 16, v10
    v_and_b32 v9, 0xffff0000, v10
    v_mul_f32 v8, 0x3e22f983, v8
    v_mul_f32 v9, 0x3e22f983, v9
    v_rndne_f32 v10, v8
    v_rndne_f32 v11, v9
    v_sub_f32 v8, v8, v10
    v_sub_f32 v9, v9, v11
    v_sin_f32 v8, v8
    v_sin_f32 v9, v9
    s_nop 0
    v_cvt_pk_bf16_f32 v10, v8, v9
    v_lshlrev_b32 v8, 16, v10
    v_and_b32 v9, 0xffff0000, v10
    v_mul_f32 v8, v8, v6
    v_mul_f32 v9, v9, v6
    v_cvt_pk_bf16_f32 v10, v8, v9
    v_lshlrev_b32 v8, 16, v10
    v_and_b32 v9, 0xffff0000, v10
    v_mul_f32 v8, v8, v7
    v_mul_f32 v9, v9, v7
    v_cvt_pk_bf16_f32 v22, v8, v9
    s_lshl_b32 s36, s35, 16
    s_and_b32 s37, s35, 0xffff0000
    v_mul_f32 v8, s36, v5
    v_mul_f32 v9, s37, v5
    v_cvt_pk_bf16_f32 v10, v8, v9
    v_lshlrev_b32 v8, 16, v10
    v_and_b32 v9, 0xffff0000, v10
    v_mul_f32 v8, 0x3e22f983, v8
    v_mul_f32 v9, 0x3e22f983, v9
    v_rndne_f32 v10, v8
    v_rndne_f32 v11, v9
    v_sub_f32 v8, v8, v10
    v_sub_f32 v9, v9, v11
    v_sin_f32 v8, v8
    v_sin_f32 v9, v9
    s_nop 0
    v_cvt_pk_bf16_f32 v10, v8, v9
    v_lshlrev_b32 v8, 16, v10
    v_and_b32 v9, 0xffff0000, v10
    v_mul_f32 v8, v8, v6
    v_mul_f32 v9, v9, v6
    v_cvt_pk_bf16_f32 v10, v8, v9
    v_lshlrev_b32 v8, 16, v10
    v_and_b32 v9, 0xffff0000, v10
    v_mul_f32 v8, v8, v7
    v_mul_f32 v9, v9, v7
    v_cvt_pk_bf16_f32 v23, v8, v9
    v_lshlrev_b32 v4, 5, v4
    buffer_store_dwordx4 v[16:19], v4, s[40:43], 0 offen sc1
    buffer_store_dwordx4 v[20:23], v4, s[40:43], 0 offen offset:16 sc1
    s_endpgm
K1_WRF:
    s_waitcnt lgkmcnt(0)
    s_mov_b32 s28, s22
    s_mov_b32 s29, s23
    s_mov_b32 s30, 12288
    s_mov_b32 s31, 0x00020000
    s_add_u32 s40, s24, 12865536
    s_addc_u32 s41, s25, 0
    s_mov_b32 s42, 24576
    s_mov_b32 s43, 0x00020000
    v_and_b32 v5, 7, v3
    v_lshrrev_b32 v6, 3, v3
    s_cmp_lt_u32 s26, 8
    s_cbranch_scc0 K1_WRF_S
    v_mul_u32_u24 v4, 3072, v2
    v_lshl_add_u32 v4, v5, 3, v4
    v_lshlrev_b32 v8, 4, v0
    s_and_b32 s3, s26, 1
    s_add_u32 s3, s3, 1
    s_lshl_b32 s3, s3, 8
    s_lshr_b32 s4, s26, 1
    s_lshl_b32 s4, s4, 6
    s_add_u32 s3, s3, s4
    v_lshl_add_u32 v4, v6, 2, v4
    buffer_load_dword v12, v4, s[28:31], s3 offen
    buffer_load_dword v13, v4, s[28:31], s3 offen offset:768
    buffer_load_dword v14, v4, s[28:31], s3 offen offset:1536
    buffer_load_dword v15, v4, s[28:31], s3 offen offset:2304
    s_waitcnt vmcnt(0)
    v_perm_b32 v16, v13, v12, s54
    v_perm_b32 v17, v15, v14, s54
    v_perm_b32 v18, v13, v12, s55
    v_perm_b32 v19, v15, v14, s55
    buffer_store_dwordx4 v[16:19], v8, s[40:43], 0 offen sc1
    s_endpgm
K1_WRF_S:
    v_and_b32 v4, 1, v2
    v_mul_u32_u24 v4, 6144, v4
    v_lshl_add_u32 v4, v5, 3, v4
    v_lshrrev_b32 v7, 1, v2
    v_cmp_ne_u32 vcc, v6, v7
    v_mov_b32 v9, 0x100000
    s_nop 0
    v_cndmask_b32 v4, v4, v9, vcc
    v_add_u32 v10, 3072, v4
    s_and_b32 s3, s26, 1
    s_lshl_b32 s3, s3, 2
    s_and_b32 s4, s26, 6
    s_lshl_b32 s4, s4, 5
    s_add_u32 s3, s3, s4
    v_add_u32 v4, s3, v4
    v_add_u32 v10, s3, v10
    s_sub_u32 s5, s26, 4
    s_lshl_b32 s5, s5, 11
    v_lshlrev_b32 v8, 4, v1
    buffer_load_dword v12, v4, s[28:31], 0 offen offset:0
    buffer_load_dword v13, v4, s[28:31], 0 offen offset:768
    buffer_load_dword v14, v4, s[28:31], 0 offen offset:1536
    buffer_load_dword v15, v4, s[28:31], 0 offen offset:2304
    buffer_load_dword v16, v10, s[28:31], 0 offen offset:0
    buffer_load_dword v17, v10, s[28:31], 0 offen offset:768
    buffer_load_dword v18, v10, s[28:31], 0 offen offset:1536
    buffer_load_dword v19, v10, s[28:31], 0 offen offset:2304
    s_waitcnt vmcnt(0)
    v_perm_b32 v24, v13, v12, s54
    v_perm_b32 v28, v13, v12, s55
    v_perm_b32 v25, v15, v14, s54
    v_perm_b32 v29, v15, v14, s55
    v_perm_b32 v26, v17, v16, s54
    v_perm_b32 v30, v17, v16, s55
    v_perm_b32 v27, v19, v18, s54
    v_perm_b32 v31, v19, v18, s55
    buffer_store_dwordx4 v[24:27], v8, s[40:43], s5 offen sc1
    buffer_store_dwordx4 v[28:31], v8, s[40:43], s5 offen offset:1024 sc1
K1_END:
    s_endpgm
.globl painn_main_kernel
.p2align 8
.type painn_main_kernel,@function
painn_main_kernel:
    s_cmp_ge_u32 s2, 256
    s_cbranch_scc1 K2_END
    s_load_dwordx2 s[24:25], s[0:1], 80
    s_load_dwordx2 s[44:45], s[0:1], 0
    s_load_dwordx2 s[48:49], s[0:1], 64
    v_lshrrev_b32 v4, 6, v0
    v_and_b32 v1, 63, v0
    v_readfirstlane_b32 s30, v4
    v_lshrrev_b32 v2, 4, v1
    v_and_b32 v3, 15, v1
    s_and_b32 s26, s2, 3
    s_lshr_b32 s27, s2, 3
    s_lshl_b32 s27, s27, 1
    s_bfe_u32 s3, s2, 0x10002
    s_add_u32 s27, s27, s3
    s_lshl_b32 s6, s27, 4
    s_add_u32 s6, s6, s30
    s_mul_i32 s7, s6, 6144
    s_add_u32 s7, s7, 110592
    s_lshl_b32 s6, s30, 8
    s_add_u32 s6, s6, s27
    s_lshl_b32 s6, s6, 2
    s_add_u32 s6, s6, 12890112
    s_add_u32 s8, s7, 3072
    v_mul_u32_u24 v100, 12, v1
    s_mov_b32 s42, 10334208
    s_mov_b32 s43, 0x00020000
    v_lshlrev_b32 v5, 4, v0
    v_mov_b64 v[104:105], 0
    v_mov_b64 v[106:107], 0
    v_add_u32 v103, 59392, v5
    v_cmp_gt_u32 vcc, 128, v0
    s_waitcnt lgkmcnt(0)
    s_add_u32 s40, s24, 12800000
    s_addc_u32 s41, s25, 0
    s_load_dword s12, s[24:25], s6
    s_load_dword s13, s[24:25], s6 offset:256
    s_load_dword s14, s[24:25], s6 offset:512
    s_load_dword s15, s[24:25], s6 offset:768
    s_mov_b32 exec_hi, 0x1fffff
    buffer_load_dwordx3 v[8:10], v100, s[40:43], s7 offen
    buffer_load_dwordx3 v[12:14], v100, s[40:43], s7 offen offset:1536
    buffer_load_dwordx3 v[16:18], v100, s[40:43], s8 offen
    buffer_load_dwordx3 v[20:22], v100, s[40:43], s8 offen offset:1536
    s_mov_b64 exec, vcc
    ds_write_b128 v5, v[104:107] offset:38912
    s_mov_b64 exec, -1
    ds_write_b128 v103, v[104:107]
    ds_write_b128 v103, v[104:107] offset:16384
    ds_write_b128 v103, v[104:107] offset:32768
    s_mul_i32 s28, s27, 157
    s_mul_i32 s10, s27, -628
    s_sub_u32 s29, 10000, s28
    s_min_u32 s29, s29, 157
    s_and_b32 s18, s26, 1
    s_mul_i32 s18, s18, 79
    s_min_u32 s18, s18, s29
    s_add_u32 s19, s18, 79
    s_min_u32 s19, s19, s29
    s_mov_b32 s46, 10240000
    s_mov_b32 s47, 0x00020000
    s_mov_b32 s50, 10240000
    s_mov_b32 s51, 0x00020000
    s_lshr_b32 s9, s26, 1
    s_mul_i32 s4, s9, 1280000
    s_add_u32 s4, s4, 10240000
    s_add_u32 s32, s24, s4
    s_addc_u32 s33, s25, 0
    s_mov_b32 s34, 1280000
    s_mov_b32 s35, 0x00020000
    v_lshlrev_b32 v101, 4, v1
    v_mov_b32 v99, 1
    s_waitcnt lgkmcnt(0)
    s_max_u32 s3, s12, s13
    s_max_u32 s4, s14, s15
    s_max_u32 s16, s3, s4
    s_mov_b32 s17, 0
    s_mov_b32 exec_hi, 0x1fffff
    v_cmp_gt_u32 s[60:61], s12, v1
    v_cmp_gt_u32 s[62:63], s13, v1
    v_cmp_gt_u32 s[64:65], s14, v1
    v_cmp_gt_u32 s[66:67], s15, v1
    s_mov_b64 exec, -1
    s_cmp_le_u32 s16, 53
    s_cbranch_scc1 K2_M_DONE
    v_mov_b32 v108, s12
    v_mov_b32 v109, s13
    v_mov_b32 v110, s14
    v_mov_b32 v111, s15
    s_mov_b32 s4, 0xffff0000
    s_mov_b32 s5, 0
    v_cndmask_b32 v108, v108, v109, s[4:5]
    s_mov_b32 s4, 0
    s_mov_b32 s5, 0xffff
    v_cndmask_b32 v108, v108, v110, s[4:5]
    s_mov_b32 s5, 0xffff0000
    v_cndmask_b32 v108, v108, v111, s[4:5]
    v_add_u32 v109, 53, v3
    v_cmp_gt_u32 s[68:69], v108, v109
    v_mul_u32_u24 v102, 1344, v2
    v_add_u32 v102, v102, v100
    s_mov_b64 exec, s[68:69]
    buffer_load_dwordx3 v[24:26], v102, s[40:43], s7 offen offset:636
    s_mov_b64 exec, -1
    s_cmp_le_u32 s16, 69
    s_cbranch_scc1 K2_M_DONE
    s_cmp_le_u32 s16, 128
    s_cbranch_scc1 K2_M_X
    s_mov_b32 s17, 1
    s_mov_b32 s16, 0
    s_mov_b64 s[60:61], 0
    s_mov_b64 s[62:63], 0
    s_mov_b64 s[64:65], 0
    s_mov_b64 s[66:67], 0
    s_branch K2_M_DONE
K2_M_X:
    v_add_u32 v109, 69, v1
    v_cmp_gt_u32 s[70:71], s12, v109
    s_nop 0
    s_mov_b64 exec, s[70:71]
    buffer_load_dwordx3 v[28:30], v100, s[40:43], s7 offen offset:828
    s_mov_b64 exec, -1
    v_cmp_gt_u32 s[72:73], s13, v109
    s_nop 0
    s_mov_b64 exec, s[72:73]
    buffer_load_dwordx3 v[32:34], v100, s[40:43], s7 offen offset:2364
    s_mov_b64 exec, -1
    v_cmp_gt_u32 s[74:75], s14, v109
    s_nop 0
    s_mov_b64 exec, s[74:75]
    buffer_load_dwordx3 v[36:38], v100, s[40:43], s8 offen offset:828
    s_mov_b64 exec, -1
    v_cmp_gt_u32 s[76:77], s15, v109
    s_nop 0
    s_mov_b64 exec, s[76:77]
    buffer_load_dwordx3 v[40:42], v100, s[40:43], s8 offen offset:2364
    s_mov_b64 exec, -1
K2_M_DONE:
    s_barrier
    s_cmp_eq_u32 s17, 0
    s_cbranch_scc1 K2_NOFLAG
    v_mov_b32 v108, 40448
    ds_write_b32 v108, v99
K2_NOFLAG:
    s_mov_b64 exec, s[60:61]
    s_waitcnt vmcnt(3)
    v_mad_u32_u16 v44, v10, 4, s10
    ds_add_rtn_u32 v11, v44, v99 offset:38912
    s_mov_b64 exec, s[62:63]
    s_waitcnt vmcnt(2)
    v_mad_u32_u16 v45, v14, 4, s10
    ds_add_rtn_u32 v15, v45, v99 offset:38912
    s_mov_b64 exec, s[64:65]
    s_waitcnt vmcnt(1)
    v_mad_u32_u16 v46, v18, 4, s10
    ds_add_rtn_u32 v19, v46, v99 offset:38912
    s_mov_b64 exec, s[66:67]
    s_waitcnt vmcnt(0)
    v_mad_u32_u16 v47, v22, 4, s10
    ds_add_rtn_u32 v23, v47, v99 offset:38912
    s_cmp_le_u32 s16, 53
    s_cbranch_scc1 K2_H_DONE
    s_mov_b64 exec, s[68:69]
    s_waitcnt vmcnt(0)
    v_mad_u32_u16 v48, v26, 4, s10
    ds_add_rtn_u32 v27, v48, v99 offset:38912
    s_cmp_le_u32 s16, 69
    s_cbranch_scc1 K2_H_DONE
    s_mov_b64 exec, s[70:71]
    v_mad_u32_u16 v49, v30, 4, s10
    ds_add_rtn_u32 v31, v49, v99 offset:38912
    s_mov_b64 exec, s[72:73]
    v_mad_u32_u16 v50, v34, 4, s10
    ds_add_rtn_u32 v35, v50, v99 offset:38912
    s_mov_b64 exec, s[74:75]
    v_mad_u32_u16 v51, v38, 4, s10
    ds_add_rtn_u32 v39, v51, v99 offset:38912
    s_mov_b64 exec, s[76:77]
    v_mad_u32_u16 v52, v42, 4, s10
    ds_add_rtn_u32 v43, v52, v99 offset:38912
K2_H_DONE:
    s_mov_b64 exec, -1
    s_cmp_lg_u32 s30, 0
    s_cbranch_scc1 K2_SETUP
    v_and_b32 v117, 16, v1
    v_and_b32 v104, 7, v3
    v_lshrrev_b32 v105, 3, v3
    v_lshlrev_b32 v116, 4, v104
    v_lshlrev_b32 v104, 3, v104
    s_lshl_b32 s3, s28, 8
    s_sub_u32 s3, 59456, s3
    v_lshl_add_u32 v118, v105, 2, v104
    v_add_u32 v118, s3, v118
    v_add_u32 v119, 59392, v104
    v_mov_b32 v4, 0x100
    v_mov_b32 v5, 0x200
    v_mov_b32 v6, 0xffff0000
    v_lshrrev_b32 v106, 2, v3
    v_lshrrev_b32 v105, 5, v1
    v_lshl_add_u32 v106, v106, 1, v105
    v_and_b32 v107, 3, v3
    v_lshlrev_b32 v107, 3, v107
    v_lshrrev_b32 v105, 3, v1
    v_add_u32 v104, 4, v1
    v_mov_b32 v103, 15
    v_writelane_b32 v103, 31, 1
    s_mov_b32 s39, 7
    s_mul_i32 s4, s26, 2560000
    s_add_u32 s36, s24, s4
    s_addc_u32 s37, s25, 0
    s_sub_u32 s20, s19, s18
    s_add_u32 s11, s28, s18
    v_mov_b32 v110, 0
    s_lshl_b32 s3, s18, 2
    v_writelane_b32 v110, s3, 1
    s_lshl_b32 s3, s29, 2
    v_mov_b32 v111, s3
    s_lshl_b32 s3, s19, 2
    v_writelane_b32 v111, s3, 1
    s_movk_i32 s3, 768
    v_writelane_b32 v111, s3, 2
    s_sub_u32 s3, 16, s30
    s_mul_i32 s3, s3, 1
    s_add_u32 s3, s3, 128
    s_mul_i32 s22, s3, s30
    s_add_u32 s4, s30, 1
    s_sub_u32 s3, s3, 1
    s_mul_i32 s23, s3, s4
    v_mov_b32 v60, 0xffff
    v_mov_b32 v61, 0
    s_add_u32 s3, s28, 159
    v_mov_b32 v62, s3
    s_waitcnt lgkmcnt(0)
    s_barrier
    ds_read_b32 v56, v100 offset:38912
    ds_read_b32 v57, v100 offset:38916
    ds_read_b32 v58, v100 offset:38920
    s_waitcnt lgkmcnt(0)
    v_add3_u32 v59, v56, v57, v58
    v_mov_b32 v96, v59
    s_nop 1
    v_add_u32_dpp v96, v96, v96 row_shr:1 row_mask:0xf bank_mask:0xf bound_ctrl:0
    s_nop 1
    v_add_u32_dpp v96, v96, v96 row_shr:2 row_mask:0xf bank_mask:0xf bound_ctrl:0
    s_nop 1
    v_add_u32_dpp v96, v96, v96 row_shr:4 row_mask:0xf bank_mask:0xf bound_ctrl:0
    s_nop 1
    v_add_u32_dpp v96, v96, v96 row_shr:8 row_mask:0xf bank_mask:0xf bound_ctrl:0
    s_nop 1
    v_add_u32_dpp v96, v96, v96 row_bcast:15 row_mask:0xa bank_mask:0xf
    s_nop 1
    v_add_u32_dpp v96, v96, v96 row_bcast:31 row_mask:0xc bank_mask:0xf
    v_add_u32 v96, 15188, v96
    v_sub_u32 v93, v96, v59
    v_readlane_b32 s3, v96, 63
    v_add_u32 v94, v93, v56
    v_add_u32 v95, v94, v57
    ds_write_b32 v100, v93 offset:39680
    ds_write_b32 v100, v94 offset:39684
    ds_write_b32 v100, v95 offset:39688
    s_cmp_gt_u32 s3, 20396
    s_cbranch_scc1 K2_NOSCAN
    v_add_u32 v93, s3, v1
    v_lshlrev_b32 v94, 3, v93
    v_lshlrev_b32 v95, 2, v93
    ds_write_b64 v94, v[60:61]
    ds_write_b32 v95, v62 offset:39616
    v_mov_b32 v93, 100364
    ds_write_b32 v93, v60
    s_branch K2_NOSCAN
K2_SETUP:
    s_waitcnt lgkmcnt(0)
    s_barrier
    v_and_b32 v117, 16, v1
    v_and_b32 v104, 7, v3
    v_lshrrev_b32 v105, 3, v3
    v_lshlrev_b32 v116, 4, v104
    v_lshlrev_b32 v104, 3, v104
    s_lshl_b32 s3, s28, 8
    s_sub_u32 s3, 59456, s3
    v_lshl_add_u32 v118, v105, 2, v104
    v_add_u32 v118, s3, v118
    v_add_u32 v119, 59392, v104
    v_mov_b32 v4, 0x100
    v_mov_b32 v5, 0x200
    v_mov_b32 v6, 0xffff0000
    v_lshrrev_b32 v106, 2, v3
    v_lshrrev_b32 v105, 5, v1
    v_lshl_add_u32 v106, v106, 1, v105
    v_and_b32 v107, 3, v3
    v_lshlrev_b32 v107, 3, v107
    v_lshrrev_b32 v105, 3, v1
    v_add_u32 v104, 4, v1
    v_mov_b32 v103, 15
    v_writelane_b32 v103, 31, 1
    s_mov_b32 s39, 7
    s_mul_i32 s4, s26, 2560000
    s_add_u32 s36, s24, s4
    s_addc_u32 s37, s25, 0
    s_sub_u32 s20, s19, s18
    s_add_u32 s11, s28, s18
    v_mov_b32 v110, 0
    s_lshl_b32 s3, s18, 2
    v_writelane_b32 v110, s3, 1
    s_lshl_b32 s3, s29, 2
    v_mov_b32 v111, s3
    s_lshl_b32 s3, s19, 2
    v_writelane_b32 v111, s3, 1
    s_movk_i32 s3, 768
    v_writelane_b32 v111, s3, 2
    s_sub_u32 s3, 16, s30
    s_mul_i32 s3, s3, 1
    s_add_u32 s3, s3, 128
    s_mul_i32 s22, s3, s30
    s_add_u32 s4, s30, 1
    s_sub_u32 s3, s3, 1
    s_mul_i32 s23, s3, s4
K2_NOSCAN:
    s_waitcnt lgkmcnt(0)
    s_barrier
    ds_read_b32 v110, v110 offset:39680
    ds_read_b32 v111, v111 offset:39680
    s_mov_b64 exec, s[60:61]
    ds_read_b32 v84, v44 offset:39680
    s_mov_b64 exec, s[62:63]
    ds_read_b32 v85, v45 offset:39680
    s_mov_b64 exec, s[64:65]
    ds_read_b32 v86, v46 offset:39680
    s_mov_b64 exec, s[66:67]
    ds_read_b32 v87, v47 offset:39680
    s_cmp_le_u32 s16, 53
    s_cbranch_scc1 K2_S1_DONE
    s_mov_b64 exec, s[68:69]
    ds_read_b32 v88, v48 offset:39680
    s_cmp_le_u32 s16, 69
    s_cbranch_scc1 K2_S1_DONE
    s_mov_b64 exec, s[70:71]
    ds_read_b32 v89, v49 offset:39680
    s_mov_b64 exec, s[72:73]
    ds_read_b32 v90, v50 offset:39680
    s_mov_b64 exec, s[74:75]
    ds_read_b32 v91, v51 offset:39680
    s_mov_b64 exec, s[76:77]
    ds_read_b32 v92, v52 offset:39680
K2_S1_DONE:
    s_mov_b64 exec, -1
    s_lshl_b32 s3, s30, 10
    s_add_u32 s4, s3, 0x4000
    s_mov_b32 m0, s3
    s_add_u32 s5, s3, 0x8000
    buffer_load_dwordx4 v101, s[40:43], s3 offen lds
    s_mov_b32 m0, s4
    s_lshl_b32 s6, s26, 11
    buffer_load_dwordx4 v101, s[40:43], s4 offen lds
    s_add_u32 s6, s6, 59392
    s_lshl_b32 s4, s9, 13
    s_add_u32 s4, s4, 65536
    s_cmp_ge_u32 s30, 8
    s_cselect_b32 s6, s4, s6
    s_add_u32 s6, s6, s3
    s_add_u32 s4, s3, 34816
    s_cmp_lt_u32 s30, 6
    s_cselect_b32 s4, s5, s4
    s_cselect_b32 s6, s5, s6
    s_mov_b32 m0, s4
    s_nop 0
    buffer_load_dwordx4 v101, s[40:43], s6 offen lds
K2_DMA0:
    s_waitcnt lgkmcnt(0)
    v_readlane_b32 s17, v111, 0
    v_readlane_b32 s3, v111, 2
    v_sub_u32 v111, v111, v110
    v_add_u32 v111, v103, v111
    v_lshrrev_b32 v111, v104, v111
    s_cmp_gt_u32 s17, 20396
    s_cbranch_scc1 K2_FALLBACK
    s_cmp_lg_u32 s3, 0
    s_cbranch_scc1 K2_FALLBACK
    s_mov_b64 exec, s[60:61]
    v_add_lshl_u32 v84, v84, v11, 2
    v_add_u32 v44, v84, v84
    ds_write_b32 v84, v10 offset:39616
    ds_write_b64 v44, v[8:9]
    s_mov_b64 exec, s[62:63]
    v_add_lshl_u32 v85, v85, v15, 2
    v_add_u32 v45, v85, v85
    ds_write_b32 v85, v14 offset:39616
    ds_write_b64 v45, v[12:13]
    s_mov_b64 exec, s[64:65]
    v_add_lshl_u32 v86, v86, v19, 2
    v_add_u32 v46, v86, v86
    ds_write_b32 v86, v18 offset:39616
    ds_write_b64 v46, v[16:17]
    s_mov_b64 exec, s[66:67]
    v_add_lshl_u32 v87, v87, v23, 2
    v_add_u32 v47, v87, v87
    ds_write_b32 v87, v22 offset:39616
    ds_write_b64 v47, v[20:21]
    s_cmp_le_u32 s16, 53
    s_cbranch_scc1 K2_S2_DONE
    s_mov_b64 exec, s[68:69]
    v_add_lshl_u32 v88, v88, v27, 2
    v_add_u32 v48, v88, v88
    ds_write_b32 v88, v26 offset:39616
    ds_write_b64 v48, v[24:25]
    s_cmp_le_u32 s16, 69
    s_cbranch_scc1 K2_S2_DONE
    s_mov_b64 exec, s[70:71]
    v_add_lshl_u32 v89, v89, v31, 2
    v_add_u32 v49, v89, v89
    ds_write_b32 v89, v30 offset:39616
    ds_write_b64 v49, v[28:29]
    s_mov_b64 exec, s[72:73]
    v_add_lshl_u32 v90, v90, v35, 2
    v_add_u32 v50, v90, v90
    ds_write_b32 v90, v34 offset:39616
    ds_write_b64 v50, v[32:33]
    s_mov_b64 exec, s[74:75]
    v_add_lshl_u32 v91, v91, v39, 2
    v_add_u32 v51, v91, v91
    ds_write_b32 v91, v38 offset:39616
    ds_write_b64 v51, v[36:37]
    s_mov_b64 exec, s[76:77]
    v_add_lshl_u32 v92, v92, v43, 2
    v_add_u32 v52, v92, v92
    ds_write_b32 v92, v42 offset:39616
    ds_write_b64 v52, v[40:41]
K2_S2_DONE:
    s_mov_b64 exec, -1
    v_mul_u32_u24 v108, s22, v111
    v_mul_u32_u24 v109, s23, v111
    v_lshrrev_b32 v108, 11, v108
    v_lshrrev_b32 v109, 11, v109
    v_sub_u32 v109, v109, v108
    v_lshl_add_u32 v108, v108, v104, v110
    v_lshlrev_b32 v110, 3, v108
    v_readlane_b32 s21, v109, 1
    v_readlane_b32 s23, v109, 0
    v_readlane_b32 s12, v110, 1
    v_readlane_b32 s14, v110, 0
    s_lshl_b32 s4, s21, 5
    s_lshl_b32 s15, s23, 5
    s_sub_u32 s13, s14, 32
    v_mul_u32_u24 v108, s4, v105
    v_mad_u32_u24 v123, s4, v106, v107
    v_mul_u32_u24 v124, s15, v2
    v_add_u32 v108, s12, v108
    v_add_u32 v123, s12, v123
    v_add_u32 v124, s13, v124
    v_lshrrev_b32 v125, 1, v108
    v_lshrrev_b32 v7, 1, v124
    s_lshl_b32 s12, s21, 4
    s_lshl_b32 s13, s23, 4
    s_cmp_gt_u32 s21, 1
    s_cbranch_scc0 K2_SHORT
    v_add_u32 v122, 32, v108
K2_SHORTRET:
    v_lshrrev_b32 v120, 1, v108
    s_mul_i32 s58, s23, 8
    s_lshr_b32 s59, s58, 6
    s_lshr_b32 s58, s58, 4
    s_max_u32 s58, s58, 1
    s_max_u32 s59, s59, 1
    s_mov_b32 s31, s23
    s_mov_b64 s[52:53], -1
    s_mov_b64 s[54:55], 0
    s_mov_b64 s[56:57], 0
    s_waitcnt vmcnt(0) lgkmcnt(0)
    s_barrier
    ds_read_u16 v84, v108 offset:0
    ds_read_u16 v85, v108 offset:8
    ds_read_u16 v86, v108 offset:16
    ds_read_u16 v87, v108 offset:24
    ds_read_u16 v121, v123 offset:4
    ds_read_b128 v[56:59], v101 offset:43008
    ds_read_b128 v[60:63], v101 offset:44032
    ds_read_b128 v[64:67], v101 offset:45056
    ds_read_b128 v[68:71], v101 offset:46080
    ds_read_b128 v[72:75], v101 offset:47104
    ds_read_b128 v[76:79], v101 offset:48128
    ds_read_b128 v[88:91], v101 offset:49152
    ds_read_b128 v[92:95], v101 offset:50176
    s_setprio 3
    v_add_u32 v123, 32, v123
    s_waitcnt lgkmcnt(9)
    v_lshl_add_u32 v111, v84, s39, v116
    buffer_load_dwordx4 v[8:11], v111, s[32:35], 0 offen
    v_lshl_add_u32 v111, v85, s39, v116
    buffer_load_dwordx4 v[12:15], v111, s[32:35], 0 offen
    v_lshl_add_u32 v111, v86, s39, v116
    buffer_load_dwordx4 v[16:19], v111, s[32:35], 0 offen
    v_lshl_add_u32 v111, v87, s39, v116
    buffer_load_dwordx4 v[20:23], v111, s[32:35], 0 offen
    s_waitcnt lgkmcnt(8)
    v_add_u32 v121, v121, v117
    ds_read_b128 v[80:83], v121
    ds_read_u16 v121, v123 offset:4
    ds_read_b32 v112, v120 offset:39616
    ds_read_u16 v84, v122 offset:0
    ds_read_b32 v113, v120 offset:39620
    ds_read_u16 v85, v122 offset:8
    ds_read_b32 v114, v120 offset:39624
    ds_read_u16 v86, v122 offset:16
    ds_read_b32 v115, v120 offset:39628
    ds_read_u16 v87, v122 offset:24
    v_mov_b64 v[96:97], 0
    v_mov_b64 v[98:99], 0
    v_mov_b64 v[100:101], 0
    v_mov_b64 v[102:103], 0
    s_waitcnt lgkmcnt(10)
    s_barrier
    s_cmp_eq_u32 s21, 0
    s_cbranch_scc1 K2_NOS
K2_SLOOP:
    s_waitcnt lgkmcnt(8)
    v_mfma_f32_16x16x32_bf16 v[24:27], v[80:83], v[56:59], 0
    v_mfma_f32_16x16x32_bf16 v[28:31], v[80:83], v[60:63], 0
    v_mfma_f32_16x16x32_bf16 v[32:35], v[80:83], v[64:67], 0
    v_mfma_f32_16x16x32_bf16 v[36:39], v[80:83], v[68:71], 0
    v_mfma_f32_16x16x32_bf16 v[40:43], v[80:83], v[72:75], 0
    v_mfma_f32_16x16x32_bf16 v[44:47], v[80:83], v[76:79], 0
    v_mfma_f32_16x16x32_bf16 v[48:51], v[80:83], v[88:91], 0
    v_mfma_f32_16x16x32_bf16 v[52:55], v[80:83], v[92:95], 0
    v_add_u32 v121, v121, v117
    v_lshrrev_b32 v120, 1, v122
    ds_read_b128 v[80:83], v121
    s_cmp_le_u32 s21, 2
    s_cbranch_scc1 K2_SEV
K2_SEVRET:
    v_add_u32 v123, 32, v123
    v_add_u32 v122, 32, v122
    ds_read_u16 v121, v123 offset:4
    s_waitcnt vmcnt(3) lgkmcnt(7)
    v_lshlrev_b64 v[104:105], 16, v[8:9]
    v_lshlrev_b64 v[106:107], 16, v[10:11]
    v_fmac_f32 v99, v8, v28
    v_fmac_f32 v98, v9, v36
    v_fmac_f32 v103, v10, v44
    v_fmac_f32 v102, v11, v52
    v_lshl_add_u32 v111, v84, s39, v116
    buffer_load_dwordx4 v[8:11], v111, s[32:35], 0 offen
    v_cmp_ne_u16 vcc, v112, v113
    v_fmac_f32 v97, v104, v24
    v_fmac_f32 v96, v105, v32
    v_fmac_f32 v101, v106, v40
    v_fmac_f32 v100, v107, v48
    s_cbranch_vccz K2_SF0
    s_mov_b64 exec, vcc
    v_subrev_u16 v110, s11, v112
    v_cvt_pk_bf16_f32 v104, v97, v99
    v_cvt_pk_bf16_f32 v105, v96, v98
    v_cvt_pk_bf16_f32 v106, v101, v103
    v_cvt_pk_bf16_f32 v107, v100, v102
    v_cmp_gt_u16 vcc, s20, v110
    v_mad_u32_u16 v110, v110, v5, v119
    v_mov_b64 v[96:97], 0
    v_mov_b64 v[98:99], 0
    v_mov_b64 v[100:101], 0
    v_mov_b64 v[102:103], 0
    s_mov_b64 exec, vcc
    ds_write2_b64 v110, v[104:105], v[106:107] offset0:0 offset1:32
    s_mov_b64 exec, -1
K2_SF0:
    ds_read_b32 v112, v120 offset:39616
    ds_read_u16 v84, v122 offset:0
    s_waitcnt vmcnt(3) lgkmcnt(7)
    v_lshlrev_b64 v[104:105], 16, v[12:13]
    v_lshlrev_b64 v[106:107], 16, v[14:15]
    v_fmac_f32 v99, v12, v29
    v_fmac_f32 v98, v13, v37
    v_fmac_f32 v103, v14, v45
    v_fmac_f32 v102, v15, v53
    v_lshl_add_u32 v111, v85, s39, v116
    buffer_load_dwordx4 v[12:15], v111, s[32:35], 0 offen
    v_cmp_ne_u16 vcc, v113, v114
    v_fmac_f32 v97, v104, v25
    v_fmac_f32 v96, v105, v33
    v_fmac_f32 v101, v106, v41
    v_fmac_f32 v100, v107, v49
    s_cbranch_vccz K2_SF1
    s_mov_b64 exec, vcc
    v_subrev_u16 v110, s11, v113
    v_cvt_pk_bf16_f32 v104, v97, v99
    v_cvt_pk_bf16_f32 v105, v96, v98
    v_cvt_pk_bf16_f32 v106, v101, v103
    v_cvt_pk_bf16_f32 v107, v100, v102
    v_cmp_gt_u16 vcc, s20, v110
    v_mad_u32_u16 v110, v110, v5, v119
    v_mov_b64 v[96:97], 0
    v_mov_b64 v[98:99], 0
    v_mov_b64 v[100:101], 0
    v_mov_b64 v[102:103], 0
    s_mov_b64 exec, vcc
    ds_write2_b64 v110, v[104:105], v[106:107] offset0:0 offset1:32
    s_mov_b64 exec, -1
K2_SF1:
    ds_read_b32 v113, v120 offset:39620
    ds_read_u16 v85, v122 offset:8
    s_waitcnt vmcnt(3) lgkmcnt(7)
    v_lshlrev_b64 v[104:105], 16, v[16:17]
    v_lshlrev_b64 v[106:107], 16, v[18:19]
    v_fmac_f32 v99, v16, v30
    v_fmac_f32 v98, v17, v38
    v_fmac_f32 v103, v18, v46
    v_fmac_f32 v102, v19, v54
    v_lshl_add_u32 v111, v86, s39, v116
    buffer_load_dwordx4 v[16:19], v111, s[32:35], 0 offen
    v_cmp_ne_u16 vcc, v114, v115
    v_fmac_f32 v97, v104, v26
    v_fmac_f32 v96, v105, v34
    v_fmac_f32 v101, v106, v42
    v_fmac_f32 v100, v107, v50
    s_cbranch_vccz K2_SF2
    s_mov_b64 exec, vcc
    v_subrev_u16 v110, s11, v114
    v_cvt_pk_bf16_f32 v104, v97, v99
    v_cvt_pk_bf16_f32 v105, v96, v98
    v_cvt_pk_bf16_f32 v106, v101, v103
    v_cvt_pk_bf16_f32 v107, v100, v102
    v_cmp_gt_u16 vcc, s20, v110
    v_mad_u32_u16 v110, v110, v5, v119
    v_mov_b64 v[96:97], 0
    v_mov_b64 v[98:99], 0
    v_mov_b64 v[100:101], 0
    v_mov_b64 v[102:103], 0
    s_mov_b64 exec, vcc
    ds_write2_b64 v110, v[104:105], v[106:107] offset0:0 offset1:32
    s_mov_b64 exec, -1
K2_SF2:
    ds_read_b32 v114, v120 offset:39624
    ds_read_u16 v86, v122 offset:16
    s_waitcnt vmcnt(3) lgkmcnt(5)
    v_lshlrev_b64 v[104:105], 16, v[20:21]
    v_lshlrev_b64 v[106:107], 16, v[22:23]
    v_fmac_f32 v99, v20, v31
    v_fmac_f32 v98, v21, v39
    v_fmac_f32 v103, v22, v47
    v_fmac_f32 v102, v23, v55
    v_lshl_add_u32 v111, v87, s39, v116
    buffer_load_dwordx4 v[20:23], v111, s[32:35], 0 offen
    v_cmp_ne_u16 vcc, v115, v112
    v_fmac_f32 v97, v104, v27
    v_fmac_f32 v96, v105, v35
    v_fmac_f32 v101, v106, v43
    v_fmac_f32 v100, v107, v51
    s_and_b64 vcc, vcc, s[52:53]
    s_cbranch_scc0 K2_SF3
    s_mov_b64 exec, vcc
    v_subrev_u16 v110, s11, v115
    v_cvt_pk_bf16_f32 v104, v97, v99
    v_cvt_pk_bf16_f32 v105, v96, v98
    v_cvt_pk_bf16_f32 v106, v101, v103
    v_cvt_pk_bf16_f32 v107, v100, v102
    v_cmp_gt_u16 vcc, s20, v110
    v_mad_u32_u16 v110, v110, v5, v119
    v_mov_b64 v[96:97], 0
    v_mov_b64 v[98:99], 0
    v_mov_b64 v[100:101], 0
    v_mov_b64 v[102:103], 0
    s_mov_b64 exec, vcc
    ds_write2_b64 v110, v[104:105], v[106:107] offset0:0 offset1:32
    s_mov_b64 exec, -1
K2_SF3:
    ds_read_b32 v115, v120 offset:39628
    ds_read_u16 v87, v122 offset:24
    s_sub_u32 s21, s21, 1
    s_cmp_lg_u32 s21, 0
    s_cbranch_scc1 K2_SLOOP
    v_add_u32 v28, 39612, v125
    v_add_u32 v29, s12, v28
    ds_read2_b32 v[24:25], v28 offset0:0 offset1:1
    ds_read2_b32 v[26:27], v29 offset0:0 offset1:1
    s_waitcnt lgkmcnt(0)
    v_mov_b32 v72, v25
    v_cmp_eq_u16 s[56:57], v24, v25
    v_cmp_eq_u16 s[4:5], v25, v26
    v_cmp_ne_u16 s[6:7], v26, v27
    v_mov_b32 v125, 1
    s_and_b64 s[4:5], s[4:5], s[56:57]
    s_andn2_b64 s[4:5], s[4:5], s[6:7]
    s_andn2_b64 s[56:57], s[56:57], s[4:5]
    v_cndmask_b32 v125, v125, 2, s[4:5]
    v_cndmask_b32 v125, v125, 0, s[6:7]
    s_mov_b64 exec, s[6:7]
    v_subrev_u16 v110, s11, v26
    v_cvt_pk_bf16_f32 v104, v97, v99
    v_cvt_pk_bf16_f32 v105, v96, v98
    v_cvt_pk_bf16_f32 v106, v101, v103
    v_cvt_pk_bf16_f32 v107, v100, v102
    v_cmp_gt_u16 vcc, s20, v110
    v_mad_u32_u16 v110, v110, v5, v119
    v_mov_b64 v[96:97], 0
    v_mov_b64 v[98:99], 0
    v_mov_b64 v[100:101], 0
    v_mov_b64 v[102:103], 0
    s_mov_b64 exec, vcc
    ds_write2_b64 v110, v[104:105], v[106:107] offset0:0 offset1:32
    s_mov_b64 exec, -1
    v_lshlrev_b32 v110, 4, v0
    v_cvt_pk_bf16_f32 v104, v97, v99
    v_cvt_pk_bf16_f32 v105, v96, v98
    v_cvt_pk_bf16_f32 v106, v101, v103
    v_cvt_pk_bf16_f32 v107, v100, v102
    ds_write_b128 v110, v[104:107] offset:43008
    v_mov_b64 v[96:97], 0
    v_mov_b64 v[98:99], 0
    v_mov_b64 v[100:101], 0
K2_SDONE:
    v_lshrrev_b32 v104, 2, v3
    v_and_b32 v105, 3, v3
    v_lshlrev_b32 v105, 3, v105
    v_mad_u32_u24 v123, s15, v104, v105
    v_add_u32 v123, s14, v123
    v_lshlrev_b32 v104, 4, v1
    ds_read_u16 v80, v123 offset:4
    ds_read_u16 v121, v123 offset:36
    ds_read_b128 v[56:59], v104 offset:40960
    ds_read_b128 v[60:63], v104 offset:41984
    v_lshlrev_b32 v117, 3, v2
    s_lshl_b32 s3, s30, 2
    s_mov_b32 s50, 10240000
    s_mov_b32 s51, 0x00020000
    s_add_u32 s4, s28, s3
    s_lshl_b32 s4, s4, 10
    s_lshl_b32 s5, s26, 6
    s_add_u32 s4, s4, s5
    s_lshl_b32 s5, s30, 1
    s_add_u32 s5, s5, s11
    s_lshl_b32 s5, s5, 10
    s_lshl_b32 s6, s9, 7
    s_add_u32 s5, s5, s6
    s_lshl_b32 s6, s20, 1
    v_add_u32 v104, s3, v2
    v_and_b32 v105, 3, v1
    v_lshrrev_b32 v106, 2, v3
    v_lshlrev_b32 v105, 4, v105
    v_lshl_add_u32 v73, v2, 10, v105
    v_lshl_add_u32 v73, v106, 8, v73
    v_add_u32 v73, s4, v73
    v_lshrrev_b32 v107, 5, v1
    v_lshl_add_u32 v107, v107, 10, v105
    v_and_b32 v108, 16, v1
    v_lshl_add_u32 v107, v108, 2, v107
    v_add_u32 v107, s5, v107
    v_cmp_eq_u32 s[4:5], 0, v106
    v_mov_b32 v108, s29
    v_mov_b32 v109, s6
    v_mov_b32 v110, 0xffff
    v_cndmask_b32 v73, v73, v107, s[4:5]
    v_cndmask_b32 v75, 4, 2, s[4:5]
    v_cndmask_b32 v108, v108, v109, s[4:5]
    v_sub_u32 v108, v108, v104
    v_add_u32 v76, v75, v75
    v_subrev_u32 v109, 64, v108
    v_cmp_lt_i32 s[4:5], 0, v108
    v_cmp_lt_i32 s[6:7], 0, v109
    v_cmp_lt_i32 s[80:81], 64, v109
    v_lshlrev_b32 v126, 4, v0
    v_add_u32 v126, 59392, v126
    v_cndmask_b32 v74, v110, 0, s[4:5]
    v_cndmask_b32 v75, v110, v75, s[6:7]
    v_cndmask_b32 v76, v110, v76, s[80:81]
    v_lshlrev_b32 v79, 3, v0
    v_add_u32 v79, 100352, v79
    v_lshlrev_b32 v82, 4, v0
    v_lshrrev_b32 v122, 4, v0
    v_lshlrev_b32 v122, 2, v122
    v_lshrrev_b32 v83, 3, v0
    v_lshlrev_b32 v83, 1, v83
    v_add_u32 v125, 1, v125
    v_subrev_u16 v78, s11, v72
    v_cmp_gt_u16 vcc, s20, v78
    s_nop 0
    s_and_b64 s[56:57], s[56:57], vcc
    v_mad_u32_u16 v78, v78, v5, v119
    v_add_u32 v104, 39628, v7
    v_add_u32 v105, s13, v104
    s_waitcnt lgkmcnt(3)
    v_add_u32 v80, v80, v117
    ds_read_b64 v[80:81], v80
    ds_write_b16 v83, v125 offset:40512
    ds_read2_b32 v[52:53], v104 offset0:0 offset1:1
    ds_read2_b32 v[54:55], v105 offset0:0 offset1:1
    s_mov_b64 exec, s[56:57]
    ds_read2_b64 v[84:87], v78 offset0:0 offset1:32
    s_mov_b64 exec, -1
    v_cmp_lt_u32 vcc, 15, v0
    s_nop 0
    s_mov_b64 s[82:83], vcc
    v_cmp_lt_u32 vcc, 7, v0
    s_nop 0
    s_and_b64 s[62:63], s[56:57], vcc
    v_mov_b32 v77, 0x100
    s_mov_b32 s38, 0
    s_mov_b64 s[52:53], -1
    s_cmp_lg_u32 s23, 0
    s_cbranch_scc1 K2_VSTART
    v_mov_b32 v7, 3
    s_cmp_lg_u32 s38, 0
    s_cbranch_scc1 K2_MSn
    s_mov_b32 s38, 1
    s_waitcnt lgkmcnt(0)
    s_mov_b64 exec, s[62:63]
    s_cbranch_execz K2_SFn_done
    v_lshlrev_b32 v64, 16, v84
    v_and_b32 v65, v6, v84
    v_lshlrev_b32 v66, 16, v85
    v_and_b32 v67, v6, v85
    v_lshlrev_b32 v68, 16, v86
    v_and_b32 v69, v6, v86
    v_lshlrev_b32 v70, 16, v87
    v_and_b32 v71, v6, v87
K2_SFn_loop:
    v_subrev_u32 v82, 0x80, v82
    v_add_u32 v83, -2, v83
    v_cmp_lt_i32 s[70:71], 0, v83
K2_SFn_poll:
    ds_read_u16 v110, v83 offset:40512
    ds_read_b128 v[104:107], v82 offset:43008
    s_waitcnt lgkmcnt(0)
    v_cmp_eq_u32 vcc, 0, v110
    v_cmp_lt_u32 s[68:69], 2, v110
    s_cbranch_vccnz K2_SFn_poll
    v_cmp_ne_u32 vcc, 4, v110
    s_and_b64 s[68:69], s[68:69], s[70:71]
    s_mov_b64 exec, vcc
    v_lshlrev_b32 v108, 16, v104
    v_and_b32 v109, v6, v104
    v_pk_add_f32 v[64:65], v[64:65], v[108:109]
    v_lshlrev_b32 v108, 16, v105
    v_and_b32 v109, v6, v105
    v_pk_add_f32 v[66:67], v[66:67], v[108:109]
    v_lshlrev_b32 v108, 16, v106
    v_and_b32 v109, v6, v106
    v_pk_add_f32 v[68:69], v[68:69], v[108:109]
    v_lshlrev_b32 v108, 16, v107
    v_and_b32 v109, v6, v107
    v_pk_add_f32 v[70:71], v[70:71], v[108:109]
    s_mov_b64 exec, s[68:69]
    s_cbranch_execnz K2_SFn_loop
    s_mov_b64 exec, s[62:63]
    v_cvt_pk_bf16_f32 v84, v64, v65
    v_cvt_pk_bf16_f32 v85, v66, v67
    v_cvt_pk_bf16_f32 v86, v68, v69
    v_cvt_pk_bf16_f32 v87, v70, v71
    ds_write2_b64 v78, v[84:85], v[86:87] offset0:0 offset1:32
K2_SFn_done:
    s_mov_b64 exec, -1
    v_mov_b32 v104, 0
    v_mov_b32 v105, 1
    s_mov_b64 exec, 1
    ds_add_u32 v104, v105 offset:40452
    s_mov_b64 exec, -1
K2_MSn:
    v_mov_b32 v77, 0x4000
    v_mad_u32_u16 v111, v74, v77, v73
    buffer_load_dwordx4 v[8:11], v111, s[44:47], 0 offen
    v_mad_u32_u16 v111, v75, v77, v73
    buffer_load_dwordx4 v[12:15], v111, s[44:47], 0 offen
    v_mad_u32_u16 v111, v76, v77, v73
    buffer_load_dwordx4 v[16:19], v111, s[44:47], 0 offen
    s_branch K2_STREAM_DONE
K2_VSTART:
    s_setprio 2
    v_lshrrev_b32 v120, 1, v124
    ds_read_b128 v[88:91], v124 offset:32
    ds_read_b128 v[92:95], v124 offset:48
    ds_read_b128 v[112:115], v120 offset:39632
    ds_read_b128 v[40:43], v124 offset:64
    ds_read_b128 v[44:47], v124 offset:80
    ds_read_b128 v[48:51], v120 offset:39648
K2_VLOOP:
    s_waitcnt lgkmcnt(3)
    v_mfma_f32_16x16x16_bf16 v[24:27], v[80:81], v[56:57], 0
    v_mfma_f32_16x16x16_bf16 v[28:31], v[80:81], v[58:59], 0
    v_mfma_f32_16x16x16_bf16 v[32:35], v[80:81], v[60:61], 0
    v_mfma_f32_16x16x16_bf16 v[36:39], v[80:81], v[62:63], 0
    v_add_u32 v121, v121, v117
    s_cmp_eq_u32 s23, s31
    ds_read_b64 v[80:81], v121
    ds_read_u16 v121, v123 offset:68
    s_cbranch_scc1 K2_EVENT0
K2_EVRET0:
    s_waitcnt vmcnt(3) lgkmcnt(4)
    v_lshlrev_b64 v[104:105], 16, v[8:9]
    v_lshlrev_b64 v[106:107], 16, v[10:11]
    v_mul_f32 v109, v11, v36
    v_mul_f32 v108, v107, v32
    v_fmac_f32 v101, v10, v28
    v_fmac_f32 v100, v106, v24
    v_pk_fma_f32 v[98:99], v[8:9], v[28:29], v[98:99] op_sel:[0,0,0] op_sel_hi:[1,0,1]
    v_mad_u32_u16 v111, v40, v77, v116
    buffer_load_dwordx4 v[8:11], v111, s[32:35], 0 offen
    v_cmp_ne_u16 vcc, v112, v113
    v_pk_fma_f32 v[96:97], v[104:105], v[24:25], v[96:97] op_sel:[0,0,0] op_sel_hi:[1,0,1]
    v_pk_fma_f32 v[100:101], v[108:109], v[112:113], v[100:101] op_sel:[0,0,0] op_sel_hi:[1,0,1]
    v_pk_fma_f32 v[98:99], v[108:109], v[88:89], v[98:99] op_sel:[1,0,0] op_sel_hi:[1,1,1]
    v_pk_fma_f32 v[96:97], v[108:109], v[88:89], v[96:97] op_sel:[0,0,0] op_sel_hi:[0,1,1]
    s_cbranch_vccz K2_VF0_0
    s_mov_b64 exec, vcc
    v_mad_u32_u16 v110, v112, v4, v118
    v_cvt_pk_bf16_f32 v104, v96, v98
    v_cvt_pk_bf16_f32 v105, v97, v99
    v_cvt_pk_bf16_f32 v106, v100, v101
    v_mov_b64 v[96:97], 0
    v_mov_b64 v[98:99], 0
    v_mov_b64 v[100:101], 0
    ds_write2_b32 v110, v104, v105 offset0:0 offset1:16
    ds_write_b32 v110, v106 offset:128
    s_mov_b64 exec, -1
K2_VF0_0:
    s_waitcnt vmcnt(3)
    v_lshlrev_b64 v[104:105], 16, v[12:13]
    v_lshlrev_b64 v[106:107], 16, v[14:15]
    v_mul_f32 v109, v15, v37
    v_mul_f32 v108, v107, v33
    v_fmac_f32 v101, v14, v29
    v_fmac_f32 v100, v106, v25
    v_pk_fma_f32 v[98:99], v[12:13], v[28:29], v[98:99] op_sel:[0,1,0] op_sel_hi:[1,1,1]
    v_mad_u32_u16 v111, v42, v77, v116
    buffer_load_dwordx4 v[12:15], v111, s[32:35], 0 offen
    v_cmp_ne_u16 vcc, v113, v114
    v_pk_fma_f32 v[96:97], v[104:105], v[24:25], v[96:97] op_sel:[0,1,0] op_sel_hi:[1,1,1]
    v_pk_fma_f32 v[100:101], v[108:109], v[112:113], v[100:101] op_sel:[0,1,0] op_sel_hi:[1,1,1]
    v_pk_fma_f32 v[98:99], v[108:109], v[90:91], v[98:99] op_sel:[1,0,0] op_sel_hi:[1,1,1]
    v_pk_fma_f32 v[96:97], v[108:109], v[90:91], v[96:97] op_sel:[0,0,0] op_sel_hi:[0,1,1]
    s_cbranch_vccz K2_VF1_0
    s_mov_b64 exec, vcc
    v_mad_u32_u16 v110, v113, v4, v118
    v_cvt_pk_bf16_f32 v104, v96, v98
    v_cvt_pk_bf16_f32 v105, v97, v99
    v_cvt_pk_bf16_f32 v106, v100, v101
    v_mov_b64 v[96:97], 0
    v_mov_b64 v[98:99], 0
    v_mov_b64 v[100:101], 0
    ds_write2_b32 v110, v104, v105 offset0:0 offset1:16
    ds_write_b32 v110, v106 offset:128
    s_mov_b64 exec, -1
K2_VF1_0:
    ds_read_b128 v[88:91], v124 offset:96
    s_waitcnt vmcnt(3) lgkmcnt(4)
    v_lshlrev_b64 v[104:105], 16, v[16:17]
    v_lshlrev_b64 v[106:107], 16, v[18:19]
    v_mul_f32 v109, v19, v38
    v_mul_f32 v108, v107, v34
    v_fmac_f32 v101, v18, v30
    v_fmac_f32 v100, v106, v26
    v_pk_fma_f32 v[98:99], v[16:17], v[30:31], v[98:99] op_sel:[0,0,0] op_sel_hi:[1,0,1]
    v_mad_u32_u16 v111, v44, v77, v116
    buffer_load_dwordx4 v[16:19], v111, s[32:35], 0 offen
    v_cmp_ne_u16 vcc, v114, v115
    v_pk_fma_f32 v[96:97], v[104:105], v[26:27], v[96:97] op_sel:[0,0,0] op_sel_hi:[1,0,1]
    v_pk_fma_f32 v[100:101], v[108:109], v[114:115], v[100:101] op_sel:[0,0,0] op_sel_hi:[1,0,1]
    v_pk_fma_f32 v[98:99], v[108:109], v[92:93], v[98:99] op_sel:[1,0,0] op_sel_hi:[1,1,1]
    v_pk_fma_f32 v[96:97], v[108:109], v[92:93], v[96:97] op_sel:[0,0,0] op_sel_hi:[0,1,1]
    s_cbranch_vccz K2_VF2_0
    s_mov_b64 exec, vcc
    v_mad_u32_u16 v110, v114, v4, v118
    v_cvt_pk_bf16_f32 v104, v96, v98
    v_cvt_pk_bf16_f32 v105, v97, v99
    v_cvt_pk_bf16_f32 v106, v100, v101
    v_mov_b64 v[96:97], 0
    v_mov_b64 v[98:99], 0
    v_mov_b64 v[100:101], 0
    ds_write2_b32 v110, v104, v105 offset0:0 offset1:16
    ds_write_b32 v110, v106 offset:128
    s_mov_b64 exec, -1
K2_VF2_0:
    s_waitcnt vmcnt(3) lgkmcnt(3)
    v_lshlrev_b64 v[104:105], 16, v[20:21]
    v_lshlrev_b64 v[106:107], 16, v[22:23]
    v_mul_f32 v109, v23, v39
    v_mul_f32 v108, v107, v35
    v_fmac_f32 v101, v22, v31
    v_fmac_f32 v100, v106, v27
    v_pk_fma_f32 v[98:99], v[20:21], v[30:31], v[98:99] op_sel:[0,1,0] op_sel_hi:[1,1,1]
    v_mad_u32_u16 v111, v46, v77, v116
    buffer_load_dwordx4 v[20:23], v111, s[32:35], 0 offen
    v_cmp_ne_u16 vcc, v115, v48
    v_pk_fma_f32 v[96:97], v[104:105], v[26:27], v[96:97] op_sel:[0,1,0] op_sel_hi:[1,1,1]
    v_pk_fma_f32 v[100:101], v[108:109], v[114:115], v[100:101] op_sel:[0,1,0] op_sel_hi:[1,1,1]
    v_pk_fma_f32 v[98:99], v[108:109], v[94:95], v[98:99] op_sel:[1,0,0] op_sel_hi:[1,1,1]
    v_pk_fma_f32 v[96:97], v[108:109], v[94:95], v[96:97] op_sel:[0,0,0] op_sel_hi:[0,1,1]
    s_and_b64 vcc, vcc, s[52:53]
    s_cbranch_scc0 K2_VF3_0
    s_mov_b64 exec, vcc
    v_mad_u32_u16 v110, v115, v4, v118
    v_cvt_pk_bf16_f32 v104, v96, v98
    v_cvt_pk_bf16_f32 v105, v97, v99
    v_cvt_pk_bf16_f32 v106, v100, v101
    v_mov_b64 v[96:97], 0
    v_mov_b64 v[98:99], 0
    v_mov_b64 v[100:101], 0
    ds_write2_b32 v110, v104, v105 offset0:0 offset1:16
    ds_write_b32 v110, v106 offset:128
    s_mov_b64 exec, -1
K2_VF3_0:
    ds_read_b128 v[92:95], v124 offset:112
    ds_read_b128 v[112:115], v120 offset:39664
    s_sub_u32 s23, s23, 1
    s_cmp_eq_u32 s23, 0
    s_cbranch_scc1 K2_VEND
    s_waitcnt lgkmcnt(3)
    v_mfma_f32_16x16x16_bf16 v[24:27], v[80:81], v[56:57], 0
    v_mfma_f32_16x16x16_bf16 v[28:31], v[80:81], v[58:59], 0
    v_mfma_f32_16x16x16_bf16 v[32:35], v[80:81], v[60:61], 0
    v_mfma_f32_16x16x16_bf16 v[36:39], v[80:81], v[62:63], 0
    v_add_u32 v121, v121, v117
    s_cmp_eq_u32 s23, s31
    ds_read_b64 v[80:81], v121
    ds_read_u16 v121, v123 offset:100
    s_cbranch_scc1 K2_EVENT1
K2_EVRET1:
    s_waitcnt vmcnt(3) lgkmcnt(4)
    v_lshlrev_b64 v[104:105], 16, v[8:9]
    v_lshlrev_b64 v[106:107], 16, v[10:11]
    v_mul_f32 v109, v11, v36
    v_mul_f32 v108, v107, v32
    v_fmac_f32 v101, v10, v28
    v_fmac_f32 v100, v106, v24
    v_pk_fma_f32 v[98:99], v[8:9], v[28:29], v[98:99] op_sel:[0,0,0] op_sel_hi:[1,0,1]
    v_mad_u32_u16 v111, v88, v77, v116
    buffer_load_dwordx4 v[8:11], v111, s[32:35], 0 offen
    v_cmp_ne_u16 vcc, v48, v49
    v_pk_fma_f32 v[96:97], v[104:105], v[24:25], v[96:97] op_sel:[0,0,0] op_sel_hi:[1,0,1]
    v_pk_fma_f32 v[100:101], v[108:109], v[48:49], v[100:101] op_sel:[0,0,0] op_sel_hi:[1,0,1]
    v_pk_fma_f32 v[98:99], v[108:109], v[40:41], v[98:99] op_sel:[1,0,0] op_sel_hi:[1,1,1]
    v_pk_fma_f32 v[96:97], v[108:109], v[40:41], v[96:97] op_sel:[0,0,0] op_sel_hi:[0,1,1]
    s_cbranch_vccz K2_VF0_1
    s_mov_b64 exec, vcc
    v_mad_u32_u16 v110, v48, v4, v118
    v_cvt_pk_bf16_f32 v104, v96, v98
    v_cvt_pk_bf16_f32 v105, v97, v99
    v_cvt_pk_bf16_f32 v106, v100, v101
    v_mov_b64 v[96:97], 0
    v_mov_b64 v[98:99], 0
    v_mov_b64 v[100:101], 0
    ds_write2_b32 v110, v104, v105 offset0:0 offset1:16
    ds_write_b32 v110, v106 offset:128
    s_mov_b64 exec, -1
K2_VF0_1:
    s_waitcnt vmcnt(3)
    v_lshlrev_b64 v[104:105], 16, v[12:13]
    v_lshlrev_b64 v[106:107], 16, v[14:15]
    v_mul_f32 v109, v15, v37
    v_mul_f32 v108, v107, v33
    v_fmac_f32 v101, v14, v29
    v_fmac_f32 v100, v106, v25
    v_pk_fma_f32 v[98:99], v[12:13], v[28:29], v[98:99] op_sel:[0,1,0] op_sel_hi:[1,1,1]
    v_mad_u32_u16 v111, v90, v77, v116
    buffer_load_dwordx4 v[12:15], v111, s[32:35], 0 offen
    v_cmp_ne_u16 vcc, v49, v50
    v_pk_fma_f32 v[96:97], v[104:105], v[24:25], v[96:97] op_sel:[0,1,0] op_sel_hi:[1,1,1]
    v_pk_fma_f32 v[100:101], v[108:109], v[48:49], v[100:101] op_sel:[0,1,0] op_sel_hi:[1,1,1]
    v_pk_fma_f32 v[98:99], v[108:109], v[42:43], v[98:99] op_sel:[1,0,0] op_sel_hi:[1,1,1]
    v_pk_fma_f32 v[96:97], v[108:109], v[42:43], v[96:97] op_sel:[0,0,0] op_sel_hi:[0,1,1]
    s_cbranch_vccz K2_VF1_1
    s_mov_b64 exec, vcc
    v_mad_u32_u16 v110, v49, v4, v118
    v_cvt_pk_bf16_f32 v104, v96, v98
    v_cvt_pk_bf16_f32 v105, v97, v99
    v_cvt_pk_bf16_f32 v106, v100, v101
    v_mov_b64 v[96:97], 0
    v_mov_b64 v[98:99], 0
    v_mov_b64 v[100:101], 0
    ds_write2_b32 v110, v104, v105 offset0:0 offset1:16
    ds_write_b32 v110, v106 offset:128
    s_mov_b64 exec, -1
K2_VF1_1:
    ds_read_b128 v[40:43], v124 offset:128
    s_waitcnt vmcnt(3) lgkmcnt(4)
    v_lshlrev_b64 v[104:105], 16, v[16:17]
    v_lshlrev_b64 v[106:107], 16, v[18:19]
    v_mul_f32 v109, v19, v38
    v_mul_f32 v108, v107, v34
    v_fmac_f32 v101, v18, v30
    v_fmac_f32 v100, v106, v26
    v_pk_fma_f32 v[98:99], v[16:17], v[30:31], v[98:99] op_sel:[0,0,0] op_sel_hi:[1,0,1]
    v_mad_u32_u16 v111, v92, v77, v116
    buffer_load_dwordx4 v[16:19], v111, s[32:35], 0 offen
    v_cmp_ne_u16 vcc, v50, v51
    v_pk_fma_f32 v[96:97], v[104:105], v[26:27], v[96:97] op_sel:[0,0,0] op_sel_hi:[1,0,1]
    v_pk_fma_f32 v[100:101], v[108:109], v[50:51], v[100:101] op_sel:[0,0,0] op_sel_hi:[1,0,1]
    v_pk_fma_f32 v[98:99], v[108:109], v[44:45], v[98:99] op_sel:[1,0,0] op_sel_hi:[1,1,1]
    v_pk_fma_f32 v[96:97], v[108:109], v[44:45], v[96:97] op_sel:[0,0,0] op_sel_hi:[0,1,1]
    s_cbranch_vccz K2_VF2_1
    s_mov_b64 exec, vcc
    v_mad_u32_u16 v110, v50, v4, v118
    v_cvt_pk_bf16_f32 v104, v96, v98
    v_cvt_pk_bf16_f32 v105, v97, v99
    v_cvt_pk_bf16_f32 v106, v100, v101
    v_mov_b64 v[96:97], 0
    v_mov_b64 v[98:99], 0
    v_mov_b64 v[100:101], 0
    ds_write2_b32 v110, v104, v105 offset0:0 offset1:16
    ds_write_b32 v110, v106 offset:128
    s_mov_b64 exec, -1
K2_VF2_1:
    s_waitcnt vmcnt(3) lgkmcnt(3)
    v_lshlrev_b64 v[104:105], 16, v[20:21]
    v_lshlrev_b64 v[106:107], 16, v[22:23]
    v_mul_f32 v109, v23, v39
    v_mul_f32 v108, v107, v35
    v_fmac_f32 v101, v22, v31
    v_fmac_f32 v100, v106, v27
    v_pk_fma_f32 v[98:99], v[20:21], v[30:31], v[98:99] op_sel:[0,1,0] op_sel_hi:[1,1,1]
    v_mad_u32_u16 v111, v94, v77, v116
    buffer_load_dwordx4 v[20:23], v111, s[32:35], 0 offen
    v_cmp_ne_u16 vcc, v51, v112
    v_pk_fma_f32 v[96:97], v[104:105], v[26:27], v[96:97] op_sel:[0,1,0] op_sel_hi:[1,1,1]
    v_pk_fma_f32 v[100:101], v[108:109], v[50:51], v[100:101] op_sel:[0,1,0] op_sel_hi:[1,1,1]
    v_pk_fma_f32 v[98:99], v[108:109], v[46:47], v[98:99] op_sel:[1,0,0] op_sel_hi:[1,1,1]
    v_pk_fma_f32 v[96:97], v[108:109], v[46:47], v[96:97] op_sel:[0,0,0] op_sel_hi:[0,1,1]
    s_and_b64 vcc, vcc, s[52:53]
    s_cbranch_scc0 K2_VF3_1
    s_mov_b64 exec, vcc
    v_mad_u32_u16 v110, v51, v4, v118
    v_cvt_pk_bf16_f32 v104, v96, v98
    v_cvt_pk_bf16_f32 v105, v97, v99
    v_cvt_pk_bf16_f32 v106, v100, v101
    v_mov_b64 v[96:97], 0
    v_mov_b64 v[98:99], 0
    v_mov_b64 v[100:101], 0
    ds_write2_b32 v110, v104, v105 offset0:0 offset1:16
    ds_write_b32 v110, v106 offset:128
    s_mov_b64 exec, -1
K2_VF3_1:
    ds_read_b128 v[44:47], v124 offset:144
    ds_read_b128 v[48:51], v120 offset:39680
    s_sub_u32 s23, s23, 1
    v_add_u32 v124, 64, v124
    v_add_u32 v120, 32, v120
    v_add_u32 v123, 64, v123
    s_cmp_lg_u32 s23, 0
    s_cbranch_scc1 K2_VLOOP
K2_VEND:
    v_cmp_eq_u16 s[54:55], v52, v53
    v_cmp_eq_u16 s[4:5], v53, v54
    v_cmp_ne_u16 s[6:7], v54, v55
    v_mov_b32 v7, 1
    s_and_b64 s[4:5], s[4:5], s[54:55]
    s_andn2_b64 s[4:5], s[4:5], s[6:7]
    s_andn2_b64 s[54:55], s[54:55], s[4:5]
    v_cndmask_b32 v7, v7, 2, s[4:5]
    v_cndmask_b32 v7, v7, 0, s[6:7]
    s_mov_b64 exec, s[6:7]
    v_mad_u32_u16 v110, v54, v4, v118
    v_cvt_pk_bf16_f32 v104, v96, v98
    v_cvt_pk_bf16_f32 v105, v97, v99
    v_cvt_pk_bf16_f32 v106, v100, v101
    v_mov_b64 v[96:97], 0
    v_mov_b64 v[98:99], 0
    v_mov_b64 v[100:101], 0
    ds_write2_b32 v110, v104, v105 offset0:0 offset1:16
    ds_write_b32 v110, v106 offset:128
    s_mov_b64 exec, -1
K2_STREAM_DONE:
    v_mov_b32 v111, 0
    v_mad_u32_u16 v125, v53, v4, v118
    s_and_b64 s[60:61], s[54:55], s[82:83]
    s_setprio 0
    v_lshlrev_b32 v79, 4, v0
    v_lshrrev_b32 v122, 1, v122
    v_add_u32 v7, 1, v7
    s_waitcnt lgkmcnt(0)
    s_mov_b64 exec, s[60:61]
    ds_read2_b32 v[40:41], v125 offset0:0 offset1:16
    ds_read_b32 v42, v125 offset:128
    s_mov_b64 exec, -1
    v_cvt_pk_bf16_f32 v104, v96, v98
    v_cvt_pk_bf16_f32 v105, v97, v99
    v_cvt_pk_bf16_f32 v106, v100, v101
K2_VC_poll:
    ds_read_b32 v110, v111 offset:40452
    s_waitcnt lgkmcnt(0)
    v_readfirstlane_b32 s3, v110
    s_nop 0
    s_cmp_lt_u32 s3, 16
    s_cbranch_scc1 K2_VC_poll
    ds_write_b128 v79, v[104:107] offset:43008
    ds_write_b16 v122, v7 offset:40768
    s_mov_b64 exec, s[60:61]
    s_cbranch_execz K2_FIN_done
    v_lshlrev_b32 v24, 16, v40
    v_and_b32 v25, v6, v40
    v_lshlrev_b32 v26, 16, v41
    v_and_b32 v27, v6, v41
    v_lshlrev_b32 v28, 16, v42
    v_and_b32 v29, v6, v42
K2_FIN_loop:
    v_subrev_u32 v79, 0x100, v79
    v_add_u32 v122, -2, v122
    v_cmp_lt_i32 s[64:65], 0, v122
    s_branch K2_FIN_rd
K2_FIN_poll:
    s_sleep 2
K2_FIN_rd:
    ds_read_u16 v110, v122 offset:40768
    ds_read_b128 v[56:59], v79 offset:43008
    s_waitcnt lgkmcnt(0)
    v_cmp_eq_u32 vcc, 0, v110
    v_cmp_lt_u32 s[66:67], 2, v110
    s_cbranch_vccnz K2_FIN_poll
    v_cmp_ne_u32 vcc, 4, v110
    s_and_b64 s[66:67], s[66:67], s[64:65]
    s_mov_b64 exec, vcc
    v_lshlrev_b32 v108, 16, v56
    v_and_b32 v109, v6, v56
    v_pk_add_f32 v[24:25], v[24:25], v[108:109]
    v_lshlrev_b32 v108, 16, v57
    v_and_b32 v109, v6, v57
    v_pk_add_f32 v[26:27], v[26:27], v[108:109]
    v_lshlrev_b32 v108, 16, v58
    v_and_b32 v109, v6, v58
    v_pk_add_f32 v[28:29], v[28:29], v[108:109]
    s_mov_b64 exec, s[66:67]
    s_cbranch_execnz K2_FIN_loop
    s_mov_b64 exec, s[60:61]
    v_cvt_pk_bf16_f32 v40, v24, v25
    v_cvt_pk_bf16_f32 v41, v26, v27
    v_cvt_pk_bf16_f32 v42, v28, v29
    ds_write2_b32 v125, v40, v41 offset0:0 offset1:16
    ds_write_b32 v125, v42 offset:128
K2_FIN_done:
    s_mov_b64 exec, -1
    s_waitcnt vmcnt(0)
    v_lshlrev_b32 v88, 16, v8
    v_and_b32 v8, v6, v8
    v_lshlrev_b32 v89, 16, v9
    v_and_b32 v9, v6, v9
    v_lshlrev_b32 v90, 16, v10
    v_and_b32 v10, v6, v10
    v_lshlrev_b32 v91, 16, v11
    v_and_b32 v11, v6, v11
    v_lshlrev_b32 v112, 16, v12
    v_and_b32 v12, v6, v12
    v_lshlrev_b32 v113, 16, v13
    v_and_b32 v13, v6, v13
    v_lshlrev_b32 v114, 16, v14
    v_and_b32 v14, v6, v14
    v_lshlrev_b32 v115, 16, v15
    v_and_b32 v15, v6, v15
    v_lshlrev_b32 v44, 16, v16
    v_and_b32 v16, v6, v16
    v_lshlrev_b32 v45, 16, v17
    v_and_b32 v17, v6, v17
    v_lshlrev_b32 v46, 16, v18
    v_and_b32 v18, v6, v18
    v_lshlrev_b32 v47, 16, v19
    v_and_b32 v19, v6, v19
    s_waitcnt lgkmcnt(0)
    s_barrier
    ds_read_b128 v[24:27], v126
    ds_read_b128 v[28:31], v126 offset:16384
    ds_read_b128 v[32:35], v126 offset:32768
K2_EPI:
    v_mad_u32_u16 v111, v74, v77, v73
    s_waitcnt lgkmcnt(2)
    v_lshlrev_b32 v106, 16, v24
    v_and_b32 v24, v6, v24
    v_add_f32 v106, v106, v88
    v_add_f32 v24, v24, v8
    v_cvt_pk_bf16_f32 v8, v106, v24
    v_lshlrev_b32 v106, 16, v25
    v_and_b32 v25, v6, v25
    v_add_f32 v106, v106, v89
    v_add_f32 v25, v25, v9
    v_cvt_pk_bf16_f32 v9, v106, v25
    v_lshlrev_b32 v106, 16, v26
    v_and_b32 v26, v6, v26
    v_add_f32 v106, v106, v90
    v_add_f32 v26, v26, v10
    v_cvt_pk_bf16_f32 v10, v106, v26
    v_lshlrev_b32 v106, 16, v27
    v_and_b32 v27, v6, v27
    v_add_f32 v106, v106, v91
    v_add_f32 v27, v27, v11
    v_cvt_pk_bf16_f32 v11, v106, v27
    buffer_store_dwordx4 v[8:11], v111, s[48:51], 0 offen nt
    v_mad_u32_u16 v111, v75, v77, v73
    s_waitcnt lgkmcnt(1)
    v_lshlrev_b32 v106, 16, v28
    v_and_b32 v28, v6, v28
    v_add_f32 v106, v106, v112
    v_add_f32 v28, v28, v12
    v_cvt_pk_bf16_f32 v12, v106, v28
    v_lshlrev_b32 v106, 16, v29
    v_and_b32 v29, v6, v29
    v_add_f32 v106, v106, v113
    v_add_f32 v29, v29, v13
    v_cvt_pk_bf16_f32 v13, v106, v29
    v_lshlrev_b32 v106, 16, v30
    v_and_b32 v30, v6, v30
    v_add_f32 v106, v106, v114
    v_add_f32 v30, v30, v14
    v_cvt_pk_bf16_f32 v14, v106, v30
    v_lshlrev_b32 v106, 16, v31
    v_and_b32 v31, v6, v31
    v_add_f32 v106, v106, v115
    v_add_f32 v31, v31, v15
    v_cvt_pk_bf16_f32 v15, v106, v31
    buffer_store_dwordx4 v[12:15], v111, s[48:51], 0 offen nt
    s_cmp_ge_u32 s30, 8
    s_cbranch_scc1 K2_EPI_DONE
    v_mad_u32_u16 v111, v76, v77, v73
    s_waitcnt lgkmcnt(0)
    v_lshlrev_b32 v106, 16, v32
    v_and_b32 v32, v6, v32
    v_add_f32 v106, v106, v44
    v_add_f32 v32, v32, v16
    v_cvt_pk_bf16_f32 v16, v106, v32
    v_lshlrev_b32 v106, 16, v33
    v_and_b32 v33, v6, v33
    v_add_f32 v106, v106, v45
    v_add_f32 v33, v33, v17
    v_cvt_pk_bf16_f32 v17, v106, v33
    v_lshlrev_b32 v106, 16, v34
    v_and_b32 v34, v6, v34
    v_add_f32 v106, v106, v46
    v_add_f32 v34, v34, v18
    v_cvt_pk_bf16_f32 v18, v106, v34
    v_lshlrev_b32 v106, 16, v35
    v_and_b32 v35, v6, v35
    v_add_f32 v106, v106, v47
    v_add_f32 v35, v35, v19
    v_cvt_pk_bf16_f32 v19, v106, v35
    buffer_store_dwordx4 v[16:19], v111, s[48:51], 0 offen nt
K2_EPI_DONE:
    s_endpgm
K2_SHORT:
    v_add_u32 v122, 32, v124
    s_cmp_eq_u32 s21, 1
    s_cbranch_scc1 K2_SHORTRET
    v_mov_b32 v108, v122
    s_mov_b32 s32, s36
    s_mov_b32 s33, s37
    s_mov_b32 s39, 8
    v_lshlrev_b32 v116, 4, v3
    s_cmp_eq_u32 s23, 0
    s_cselect_b32 s34, 0, 2560000
    s_branch K2_SHORTRET
K2_SEV:
    s_cmp_eq_u32 s21, 2
    s_cbranch_scc0 K2_SEV1
    v_mov_b32 v122, v124
    s_branch K2_SEVRET
K2_SEV1:
    s_mov_b64 s[52:53], 0
    s_mov_b32 s32, s36
    s_mov_b32 s33, s37
    s_mov_b32 s39, 8
    v_lshlrev_b32 v116, 4, v3
    s_cmp_eq_u32 s23, 0
    s_cselect_b32 s34, 0, 2560000
    s_branch K2_SEVRET
K2_EVENT0:
    s_cmp_gt_u32 s23, s58
    s_cselect_b32 s31, s58, s59
    s_cbranch_scc1 K2_EVRET0
    s_cmp_lg_u32 s38, 0
    s_cbranch_scc1 K2_MS0
    s_mov_b32 s38, 1
    s_waitcnt lgkmcnt(0)
    s_mov_b64 exec, s[62:63]
    s_cbranch_execz K2_SF0_done
    v_lshlrev_b32 v64, 16, v84
    v_and_b32 v65, v6, v84
    v_lshlrev_b32 v66, 16, v85
    v_and_b32 v67, v6, v85
    v_lshlrev_b32 v68, 16, v86
    v_and_b32 v69, v6, v86
    v_lshlrev_b32 v70, 16, v87
    v_and_b32 v71, v6, v87
K2_SF0_loop:
    v_subrev_u32 v82, 0x80, v82
    v_add_u32 v83, -2, v83
    v_cmp_lt_i32 s[70:71], 0, v83
K2_SF0_poll:
    ds_read_u16 v110, v83 offset:40512
    ds_read_b128 v[104:107], v82 offset:43008
    s_waitcnt lgkmcnt(0)
    v_cmp_eq_u32 vcc, 0, v110
    v_cmp_lt_u32 s[68:69], 2, v110
    s_cbranch_vccnz K2_SF0_poll
    v_cmp_ne_u32 vcc, 4, v110
    s_and_b64 s[68:69], s[68:69], s[70:71]
    s_mov_b64 exec, vcc
    v_lshlrev_b32 v108, 16, v104
    v_and_b32 v109, v6, v104
    v_pk_add_f32 v[64:65], v[64:65], v[108:109]
    v_lshlrev_b32 v108, 16, v105
    v_and_b32 v109, v6, v105
    v_pk_add_f32 v[66:67], v[66:67], v[108:109]
    v_lshlrev_b32 v108, 16, v106
    v_and_b32 v109, v6, v106
    v_pk_add_f32 v[68:69], v[68:69], v[108:109]
    v_lshlrev_b32 v108, 16, v107
    v_and_b32 v109, v6, v107
    v_pk_add_f32 v[70:71], v[70:71], v[108:109]
    s_mov_b64 exec, s[68:69]
    s_cbranch_execnz K2_SF0_loop
    s_mov_b64 exec, s[62:63]
    v_cvt_pk_bf16_f32 v84, v64, v65
    v_cvt_pk_bf16_f32 v85, v66, v67
    v_cvt_pk_bf16_f32 v86, v68, v69
    v_cvt_pk_bf16_f32 v87, v70, v71
    ds_write2_b64 v78, v[84:85], v[86:87] offset0:0 offset1:32
K2_SF0_done:
    s_mov_b64 exec, -1
    v_mov_b32 v104, 0
    v_mov_b32 v105, 1
    s_mov_b64 exec, 1
    ds_add_u32 v104, v105 offset:40452
    s_mov_b64 exec, -1
K2_MS0:
    s_setprio 1
    s_cmp_gt_u32 s23, s59
    s_cbranch_scc1 K2_EVRET0
    s_setprio 0
    s_mov_b32 s31, 1
    s_cmp_gt_u32 s23, 1
    s_cbranch_scc1 K2_EVRET0
    s_mov_b32 s32, s44
    s_mov_b32 s33, s45
    s_mov_b32 s34, s46
    s_mov_b64 s[52:53], 0
    s_waitcnt lgkmcnt(0)
    v_mov_b32 v77, 16384
    v_mov_b32 v116, v73
    v_mov_b32 v40, v74
    v_mov_b32 v42, v75
    v_mov_b32 v44, v76
    v_mov_b32 v46, 0xffff
    s_branch K2_EVRET0
K2_EVENT1:
    s_cmp_gt_u32 s23, s58
    s_cselect_b32 s31, s58, s59
    s_cbranch_scc1 K2_EVRET1
    s_cmp_lg_u32 s38, 0
    s_cbranch_scc1 K2_MS1
    s_mov_b32 s38, 1
    s_waitcnt lgkmcnt(0)
    s_mov_b64 exec, s[62:63]
    s_cbranch_execz K2_SF1_done
    v_lshlrev_b32 v64, 16, v84
    v_and_b32 v65, v6, v84
    v_lshlrev_b32 v66, 16, v85
    v_and_b32 v67, v6, v85
    v_lshlrev_b32 v68, 16, v86
    v_and_b32 v69, v6, v86
    v_lshlrev_b32 v70, 16, v87
    v_and_b32 v71, v6, v87
K2_SF1_loop:
    v_subrev_u32 v82, 0x80, v82
    v_add_u32 v83, -2, v83
    v_cmp_lt_i32 s[70:71], 0, v83
K2_SF1_poll:
    ds_read_u16 v110, v83 offset:40512
    ds_read_b128 v[104:107], v82 offset:43008
    s_waitcnt lgkmcnt(0)
    v_cmp_eq_u32 vcc, 0, v110
    v_cmp_lt_u32 s[68:69], 2, v110
    s_cbranch_vccnz K2_SF1_poll
    v_cmp_ne_u32 vcc, 4, v110
    s_and_b64 s[68:69], s[68:69], s[70:71]
    s_mov_b64 exec, vcc
    v_lshlrev_b32 v108, 16, v104
    v_and_b32 v109, v6, v104
    v_pk_add_f32 v[64:65], v[64:65], v[108:109]
    v_lshlrev_b32 v108, 16, v105
    v_and_b32 v109, v6, v105
    v_pk_add_f32 v[66:67], v[66:67], v[108:109]
    v_lshlrev_b32 v108, 16, v106
    v_and_b32 v109, v6, v106
    v_pk_add_f32 v[68:69], v[68:69], v[108:109]
    v_lshlrev_b32 v108, 16, v107
    v_and_b32 v109, v6, v107
    v_pk_add_f32 v[70:71], v[70:71], v[108:109]
    s_mov_b64 exec, s[68:69]
    s_cbranch_execnz K2_SF1_loop
    s_mov_b64 exec, s[62:63]
    v_cvt_pk_bf16_f32 v84, v64, v65
    v_cvt_pk_bf16_f32 v85, v66, v67
    v_cvt_pk_bf16_f32 v86, v68, v69
    v_cvt_pk_bf16_f32 v87, v70, v71
    ds_write2_b64 v78, v[84:85], v[86:87] offset0:0 offset1:32
K2_SF1_done:
    s_mov_b64 exec, -1
    v_mov_b32 v104, 0
    v_mov_b32 v105, 1
    s_mov_b64 exec, 1
    ds_add_u32 v104, v105 offset:40452
    s_mov_b64 exec, -1
K2_MS1:
    s_setprio 1
    s_cmp_gt_u32 s23, s59
    s_cbranch_scc1 K2_EVRET1
    s_setprio 0
    s_mov_b32 s31, 1
    s_cmp_gt_u32 s23, 1
    s_cbranch_scc1 K2_EVRET1
    s_mov_b32 s32, s44
    s_mov_b32 s33, s45
    s_mov_b32 s34, s46
    s_mov_b64 s[52:53], 0
    s_waitcnt lgkmcnt(0)
    v_mov_b32 v77, 16384
    v_mov_b32 v116, v73
    v_mov_b32 v88, v74
    v_mov_b32 v90, v75
    v_mov_b32 v92, v76
    v_mov_b32 v94, 0xffff
    s_branch K2_EVRET1
K2_NOS:
    v_mov_b32 v125, 3
    s_waitcnt vmcnt(4) lgkmcnt(0)
    s_branch K2_SDONE
K2_FALLBACK:
    s_mov_b64 exec, -1
    s_lshl_b32 s6, s30, 8
    s_add_u32 s6, s6, s27
    s_lshl_b32 s6, s6, 2
    s_lshl_b32 s3, s30, 4
    s_add_u32 s6, s6, 12890112
    s_add_u32 s3, s3, 12906496
    s_load_dword s60, s[24:25], s6
    s_load_dword s61, s[24:25], s6 offset:256
    s_load_dword s62, s[24:25], s6 offset:512
    s_load_dword s63, s[24:25], s6 offset:768
    s_load_dwordx4 s[64:67], s[24:25], s3
    s_mov_b32 s76, s36
    s_mov_b32 s77, s37
    s_mov_b32 s78, 2560000
    s_mov_b32 s79, 0x00020000
    v_mov_b64 v[104:105], 0
    v_mov_b64 v[106:107], 0
    v_lshlrev_b32 v108, 4, v0
    v_add_u32 v108, 81920, v108
    v_add_u32 v109, 0x10000, v108
    s_waitcnt vmcnt(0)
    v_lshlrev_b32 v126, 4, v1
    s_barrier
    ds_read_b128 v[56:59], v126 offset:43008
    ds_read_b128 v[60:63], v126 offset:44032
    ds_read_b128 v[64:67], v126 offset:45056
    ds_read_b128 v[68:71], v126 offset:46080
    ds_read_b128 v[72:75], v126 offset:47104
    ds_read_b128 v[76:79], v126 offset:48128
    ds_read_b128 v[100:103], v126 offset:49152
    ds_read_b128 v[112:115], v126 offset:50176
    ds_write_b128 v108, v[104:107] offset:0
    ds_write_b128 v108, v[104:107] offset:16384
    ds_write_b128 v108, v[104:107] offset:32768
    ds_write_b128 v108, v[104:107] offset:49152
    ds_write_b128 v109, v[104:107]
    v_mul_u32_u24 v125, 12, v3
    v_mul_u32_u24 v124, 48, v2
    v_lshlrev_b32 v7, 4, v3
    v_cmp_gt_u32 s[84:85], 8, v3
    v_subrev_u32 v118, 59392, v118
    v_subrev_u32 v119, 59392, v119
    s_mul_i32 s8, s30, 245760
    s_add_u32 s8, s8, 6402048
    s_mov_b32 s12, 0
    s_waitcnt lgkmcnt(0)
    s_barrier
    s_and_b32 s60, s60, 0xffff
    s_min_u32 s60, s60, 128
    s_min_u32 s64, s64, 5120
    s_and_b32 s61, s61, 0xffff
    s_min_u32 s61, s61, 128
    s_min_u32 s65, s65, 5120
    s_and_b32 s62, s62, 0xffff
    s_min_u32 s62, s62, 128
    s_min_u32 s66, s66, 5120
    s_and_b32 s63, s63, 0xffff
    s_min_u32 s63, s63, 128
    s_min_u32 s67, s67, 5120
K2_FB_SEG:
    s_mov_b32 s14, s60
    s_mov_b32 s60, s61
    s_mov_b32 s61, s62
    s_mov_b32 s62, s63
    s_mov_b32 s63, s64
    s_mov_b32 s64, s65
    s_mov_b32 s65, s66
    s_mov_b32 s66, s67
    s_mul_i32 s13, s12, 1536
    s_add_u32 s13, s13, s7
    s_sub_u32 s3, s12, 4
    s_mul_i32 s3, s3, 61440
    s_add_u32 s3, s3, s8
    s_cmp_ge_u32 s12, 4
    s_cselect_b32 s13, s3, s13
K2_FB_BATCH:
    s_cmp_le_i32 s14, 0
    s_cbranch_scc1 K2_FB_NEXT
    buffer_load_dword v82, v125, s[40:43], s13 offen offset:4
    ds_read_b128 v[48:51], v126 offset:40960
    ds_read_b128 v[52:55], v126 offset:41984
    buffer_load_dwordx3 v[84:86], v124, s[40:43], s13 offen offset:0
    buffer_load_dwordx3 v[88:90], v124, s[40:43], s13 offen offset:12
    buffer_load_dwordx3 v[92:94], v124, s[40:43], s13 offen offset:24
    buffer_load_dwordx3 v[96:98], v124, s[40:43], s13 offen offset:36
    s_waitcnt vmcnt(4)
    v_and_b32 v82, 0xffff, v82
    v_lshl_add_u32 v83, v2, 3, v82
    v_add_u32 v82, v82, v117
    buffer_load_dwordx2 v[80:81], v83, s[40:43], 0 offen
    buffer_load_dwordx4 v[120:123], v82, s[40:43], 0 offen
    s_waitcnt vmcnt(2)
    v_mad_u32_u16 v87, v84, v4, v7
    buffer_load_dwordx4 v[8:11], v87, s[76:79], 0 offen
    v_lshl_add_u32 v104, v2, 2, 0
    v_cmp_gt_i32 s[68:69], s14, v104
    v_subrev_u16 v104, s28, v86
    v_cmp_gt_u16 vcc, s29, v104
    s_nop 0
    s_and_b64 s[68:69], s[68:69], vcc
    v_and_b32 v87, 0xffff, v84
    v_lshl_add_u32 v87, v87, 7, v116
    v_mad_u32_u16 v91, v88, v4, v7
    buffer_load_dwordx4 v[12:15], v91, s[76:79], 0 offen
    v_lshl_add_u32 v104, v2, 2, 1
    v_cmp_gt_i32 s[70:71], s14, v104
    v_subrev_u16 v104, s28, v90
    v_cmp_gt_u16 vcc, s29, v104
    s_nop 0
    s_and_b64 s[70:71], s[70:71], vcc
    v_and_b32 v91, 0xffff, v88
    v_lshl_add_u32 v91, v91, 7, v116
    v_mad_u32_u16 v95, v92, v4, v7
    buffer_load_dwordx4 v[16:19], v95, s[76:79], 0 offen
    v_lshl_add_u32 v104, v2, 2, 2
    v_cmp_gt_i32 s[72:73], s14, v104
    v_subrev_u16 v104, s28, v94
    v_cmp_gt_u16 vcc, s29, v104
    s_nop 0
    s_and_b64 s[72:73], s[72:73], vcc
    v_and_b32 v95, 0xffff, v92
    v_lshl_add_u32 v95, v95, 7, v116
    v_mad_u32_u16 v99, v96, v4, v7
    buffer_load_dwordx4 v[20:23], v99, s[76:79], 0 offen
    v_lshl_add_u32 v104, v2, 2, 3
    v_cmp_gt_i32 s[74:75], s14, v104
    v_subrev_u16 v104, s28, v98
    v_cmp_gt_u16 vcc, s29, v104
    s_nop 0
    s_and_b64 s[74:75], s[74:75], vcc
    v_and_b32 v99, 0xffff, v96
    v_lshl_add_u32 v99, v99, 7, v116
    s_waitcnt vmcnt(4) lgkmcnt(0)
    v_mfma_f32_16x16x16_bf16 v[24:27], v[80:81], v[48:49], 0
    v_mfma_f32_16x16x16_bf16 v[28:31], v[80:81], v[50:51], 0
    v_mfma_f32_16x16x16_bf16 v[32:35], v[80:81], v[52:53], 0
    v_mfma_f32_16x16x16_bf16 v[36:39], v[80:81], v[54:55], 0
    s_waitcnt vmcnt(0)
    v_lshlrev_b64 v[104:105], 16, v[8:9]
    v_lshlrev_b64 v[106:107], 16, v[10:11]
    s_nop 3
    v_mul_f32 v108, v107, v32
    v_mul_f32 v109, v11, v36
    v_mad_u32_u16 v110, v86, v4, v118
    v_lshlrev_b32 v110, 1, v110
    v_add_u32 v110, 81920, v110
    v_mul_f32 v40, v104, v24
    v_fmac_f32 v40, v108, v84
    v_mul_f32 v41, v8, v28
    v_fmac_f32 v41, v109, v84
    v_mul_f32 v42, v105, v24
    v_fmac_f32 v42, v108, v85
    v_mul_f32 v43, v9, v28
    v_fmac_f32 v43, v109, v85
    v_mul_f32 v44, v106, v24
    v_fmac_f32 v44, v108, v86
    v_mul_f32 v45, v10, v28
    v_fmac_f32 v45, v109, v86
    buffer_load_dwordx4 v[8:11], v87, s[32:35], 0 offen
    s_mov_b64 exec, s[68:69]
    ds_add_f32 v110, v40 offset:0
    ds_add_f32 v110, v41 offset:4
    ds_add_f32 v110, v42 offset:128
    ds_add_f32 v110, v43 offset:132
    ds_add_f32 v110, v44 offset:256
    ds_add_f32 v110, v45 offset:260
    s_mov_b64 exec, -1
    s_waitcnt lgkmcnt(0)
    v_lshlrev_b64 v[104:105], 16, v[12:13]
    v_lshlrev_b64 v[106:107], 16, v[14:15]
    v_mul_f32 v108, v107, v33
    v_mul_f32 v109, v15, v37
    v_mad_u32_u16 v110, v90, v4, v118
    v_lshlrev_b32 v110, 1, v110
    v_add_u32 v110, 81920, v110
    v_mul_f32 v40, v104, v25
    v_fmac_f32 v40, v108, v88
    v_mul_f32 v41, v12, v29
    v_fmac_f32 v41, v109, v88
    v_mul_f32 v42, v105, v25
    v_fmac_f32 v42, v108, v89
    v_mul_f32 v43, v13, v29
    v_fmac_f32 v43, v109, v89
    v_mul_f32 v44, v106, v25
    v_fmac_f32 v44, v108, v90
    v_mul_f32 v45, v14, v29
    v_fmac_f32 v45, v109, v90
    buffer_load_dwordx4 v[12:15], v91, s[32:35], 0 offen
    s_mov_b64 exec, s[70:71]
    ds_add_f32 v110, v40 offset:0
    ds_add_f32 v110, v41 offset:4
    ds_add_f32 v110, v42 offset:128
    ds_add_f32 v110, v43 offset:132
    ds_add_f32 v110, v44 offset:256
    ds_add_f32 v110, v45 offset:260
    s_mov_b64 exec, -1
    s_waitcnt lgkmcnt(0)
    v_lshlrev_b64 v[104:105], 16, v[16:17]
    v_lshlrev_b64 v[106:107], 16, v[18:19]
    v_mul_f32 v108, v107, v34
    v_mul_f32 v109, v19, v38
    v_mad_u32_u16 v110, v94, v4, v118
    v_lshlrev_b32 v110, 1, v110
    v_add_u32 v110, 81920, v110
    v_mul_f32 v40, v104, v26
    v_fmac_f32 v40, v108, v92
    v_mul_f32 v41, v16, v30
    v_fmac_f32 v41, v109, v92
    v_mul_f32 v42, v105, v26
    v_fmac_f32 v42, v108, v93
    v_mul_f32 v43, v17, v30
    v_fmac_f32 v43, v109, v93
    v_mul_f32 v44, v106, v26
    v_fmac_f32 v44, v108, v94
    v_mul_f32 v45, v18, v30
    v_fmac_f32 v45, v109, v94
    buffer_load_dwordx4 v[16:19], v95, s[32:35], 0 offen
    s_mov_b64 exec, s[72:73]
    ds_add_f32 v110, v40 offset:0
    ds_add_f32 v110, v41 offset:4
    ds_add_f32 v110, v42 offset:128
    ds_add_f32 v110, v43 offset:132
    ds_add_f32 v110, v44 offset:256
    ds_add_f32 v110, v45 offset:260
    s_mov_b64 exec, -1
    s_waitcnt lgkmcnt(0)
    v_lshlrev_b64 v[104:105], 16, v[20:21]
    v_lshlrev_b64 v[106:107], 16, v[22:23]
    v_mul_f32 v108, v107, v35
    v_mul_f32 v109, v23, v39
    v_mad_u32_u16 v110, v98, v4, v118
    v_lshlrev_b32 v110, 1, v110
    v_add_u32 v110, 81920, v110
    v_mul_f32 v40, v104, v27
    v_fmac_f32 v40, v108, v96
    v_mul_f32 v41, v20, v31
    v_fmac_f32 v41, v109, v96
    v_mul_f32 v42, v105, v27
    v_fmac_f32 v42, v108, v97
    v_mul_f32 v43, v21, v31
    v_fmac_f32 v43, v109, v97
    v_mul_f32 v44, v106, v27
    v_fmac_f32 v44, v108, v98
    v_mul_f32 v45, v22, v31
    v_fmac_f32 v45, v109, v98
    buffer_load_dwordx4 v[20:23], v99, s[32:35], 0 offen
    s_mov_b64 exec, s[74:75]
    ds_add_f32 v110, v40 offset:0
    ds_add_f32 v110, v41 offset:4
    ds_add_f32 v110, v42 offset:128
    ds_add_f32 v110, v43 offset:132
    ds_add_f32 v110, v44 offset:256
    ds_add_f32 v110, v45 offset:260
    s_mov_b64 exec, -1
    s_waitcnt lgkmcnt(0)
    v_mfma_f32_16x16x32_bf16 v[24:27], v[120:123], v[56:59], 0
    v_mfma_f32_16x16x32_bf16 v[28:31], v[120:123], v[60:63], 0
    v_mfma_f32_16x16x32_bf16 v[32:35], v[120:123], v[64:67], 0
    v_mfma_f32_16x16x32_bf16 v[36:39], v[120:123], v[68:71], 0
    v_mfma_f32_16x16x32_bf16 v[40:43], v[120:123], v[72:75], 0
    v_mfma_f32_16x16x32_bf16 v[44:47], v[120:123], v[76:79], 0
    v_mfma_f32_16x16x32_bf16 v[48:51], v[120:123], v[100:103], 0
    v_mfma_f32_16x16x32_bf16 v[52:55], v[120:123], v[112:115], 0
    s_waitcnt vmcnt(0)
    v_lshlrev_b64 v[104:105], 16, v[8:9]
    v_lshlrev_b64 v[106:107], 16, v[10:11]
    v_subrev_u16 v110, s11, v86
    v_cmp_gt_u16 vcc, s20, v110
    v_mad_u32_u16 v110, v110, v5, v119
    v_lshlrev_b32 v110, 1, v110
    v_add_u32 v110, 81920, v110
    s_and_b64 vcc, vcc, s[84:85]
    v_mul_f32 v104, v104, v24
    v_mul_f32 v8, v8, v28
    v_mul_f32 v105, v105, v32
    v_mul_f32 v9, v9, v36
    v_mul_f32 v106, v106, v40
    v_mul_f32 v10, v10, v44
    v_mul_f32 v107, v107, v48
    v_mul_f32 v11, v11, v52
    s_and_b64 exec, vcc, s[68:69]
    ds_add_f32 v110, v104 offset:0
    ds_add_f32 v110, v8 offset:4
    ds_add_f32 v110, v105 offset:8
    ds_add_f32 v110, v9 offset:12
    ds_add_f32 v110, v106 offset:512
    ds_add_f32 v110, v10 offset:516
    ds_add_f32 v110, v107 offset:520
    ds_add_f32 v110, v11 offset:524
    s_mov_b64 exec, -1
    s_waitcnt lgkmcnt(0)
    v_lshlrev_b64 v[104:105], 16, v[12:13]
    v_lshlrev_b64 v[106:107], 16, v[14:15]
    v_subrev_u16 v110, s11, v90
    v_cmp_gt_u16 vcc, s20, v110
    v_mad_u32_u16 v110, v110, v5, v119
    v_lshlrev_b32 v110, 1, v110
    v_add_u32 v110, 81920, v110
    s_and_b64 vcc, vcc, s[84:85]
    v_mul_f32 v104, v104, v25
    v_mul_f32 v12, v12, v29
    v_mul_f32 v105, v105, v33
    v_mul_f32 v13, v13, v37
    v_mul_f32 v106, v106, v41
    v_mul_f32 v14, v14, v45
    v_mul_f32 v107, v107, v49
    v_mul_f32 v15, v15, v53
    s_and_b64 exec, vcc, s[70:71]
    ds_add_f32 v110, v104 offset:0
    ds_add_f32 v110, v12 offset:4
    ds_add_f32 v110, v105 offset:8
    ds_add_f32 v110, v13 offset:12
    ds_add_f32 v110, v106 offset:512
    ds_add_f32 v110, v14 offset:516
    ds_add_f32 v110, v107 offset:520
    ds_add_f32 v110, v15 offset:524
    s_mov_b64 exec, -1
    s_waitcnt lgkmcnt(0)
    v_lshlrev_b64 v[104:105], 16, v[16:17]
    v_lshlrev_b64 v[106:107], 16, v[18:19]
    v_subrev_u16 v110, s11, v94
    v_cmp_gt_u16 vcc, s20, v110
    v_mad_u32_u16 v110, v110, v5, v119
    v_lshlrev_b32 v110, 1, v110
    v_add_u32 v110, 81920, v110
    s_and_b64 vcc, vcc, s[84:85]
    v_mul_f32 v104, v104, v26
    v_mul_f32 v16, v16, v30
    v_mul_f32 v105, v105, v34
    v_mul_f32 v17, v17, v38
    v_mul_f32 v106, v106, v42
    v_mul_f32 v18, v18, v46
    v_mul_f32 v107, v107, v50
    v_mul_f32 v19, v19, v54
    s_and_b64 exec, vcc, s[72:73]
    ds_add_f32 v110, v104 offset:0
    ds_add_f32 v110, v16 offset:4
    ds_add_f32 v110, v105 offset:8
    ds_add_f32 v110, v17 offset:12
    ds_add_f32 v110, v106 offset:512
    ds_add_f32 v110, v18 offset:516
    ds_add_f32 v110, v107 offset:520
    ds_add_f32 v110, v19 offset:524
    s_mov_b64 exec, -1
    s_waitcnt lgkmcnt(0)
    v_lshlrev_b64 v[104:105], 16, v[20:21]
    v_lshlrev_b64 v[106:107], 16, v[22:23]
    v_subrev_u16 v110, s11, v98
    v_cmp_gt_u16 vcc, s20, v110
    v_mad_u32_u16 v110, v110, v5, v119
    v_lshlrev_b32 v110, 1, v110
    v_add_u32 v110, 81920, v110
    s_and_b64 vcc, vcc, s[84:85]
    v_mul_f32 v104, v104, v27
    v_mul_f32 v20, v20, v31
    v_mul_f32 v105, v105, v35
    v_mul_f32 v21, v21, v39
    v_mul_f32 v106, v106, v43
    v_mul_f32 v22, v22, v47
    v_mul_f32 v107, v107, v51
    v_mul_f32 v23, v23, v55
    s_and_b64 exec, vcc, s[74:75]
    ds_add_f32 v110, v104 offset:0
    ds_add_f32 v110, v20 offset:4
    ds_add_f32 v110, v105 offset:8
    ds_add_f32 v110, v21 offset:12
    ds_add_f32 v110, v106 offset:512
    ds_add_f32 v110, v22 offset:516
    ds_add_f32 v110, v107 offset:520
    ds_add_f32 v110, v23 offset:524
    s_mov_b64 exec, -1
    s_waitcnt lgkmcnt(0)
    s_add_u32 s13, s13, 192
    s_sub_u32 s14, s14, 16
    s_branch K2_FB_BATCH
K2_FB_NEXT:
    s_add_u32 s12, s12, 1
    s_cmp_lt_u32 s12, 8
    s_cbranch_scc1 K2_FB_SEG
    s_lshl_b32 s3, s30, 2
    s_mov_b32 s50, 10240000
    s_mov_b32 s51, 0x00020000
    s_add_u32 s4, s28, s3
    s_lshl_b32 s4, s4, 10
    s_lshl_b32 s5, s26, 6
    s_add_u32 s4, s4, s5
    s_lshl_b32 s5, s30, 1
    s_add_u32 s5, s5, s11
    s_lshl_b32 s5, s5, 10
    s_lshl_b32 s6, s9, 7
    s_add_u32 s5, s5, s6
    s_lshl_b32 s6, s20, 1
    v_add_u32 v104, s3, v2
    v_and_b32 v105, 3, v1
    v_lshrrev_b32 v106, 2, v3
    v_lshlrev_b32 v105, 4, v105
    v_lshl_add_u32 v73, v2, 10, v105
    v_lshl_add_u32 v73, v106, 8, v73
    v_add_u32 v73, s4, v73
    v_lshrrev_b32 v107, 5, v1
    v_lshl_add_u32 v107, v107, 10, v105
    v_and_b32 v108, 16, v1
    v_lshl_add_u32 v107, v108, 2, v107
    v_add_u32 v107, s5, v107
    v_cmp_eq_u32 s[4:5], 0, v106
    v_mov_b32 v108, s29
    v_mov_b32 v109, s6
    v_mov_b32 v110, 0xffff
    v_cndmask_b32 v73, v73, v107, s[4:5]
    v_cndmask_b32 v75, 4, 2, s[4:5]
    v_cndmask_b32 v108, v108, v109, s[4:5]
    v_sub_u32 v108, v108, v104
    v_add_u32 v76, v75, v75
    v_subrev_u32 v109, 64, v108
    v_cmp_lt_i32 s[4:5], 0, v108
    v_cmp_lt_i32 s[6:7], 0, v109
    v_cmp_lt_i32 s[80:81], 64, v109
    v_lshlrev_b32 v126, 4, v0
    v_add_u32 v126, 59392, v126
    v_cndmask_b32 v74, v110, 0, s[4:5]
    v_cndmask_b32 v75, v110, v75, s[6:7]
    v_cndmask_b32 v76, v110, v76, s[80:81]
    v_mov_b32 v77, 0x4000
    v_mad_u32_u16 v111, v74, v77, v73
    buffer_load_dwordx4 v[8:11], v111, s[44:47], 0 offen
    v_mad_u32_u16 v111, v75, v77, v73
    buffer_load_dwordx4 v[12:15], v111, s[44:47], 0 offen
    v_mad_u32_u16 v111, v76, v77, v73
    buffer_load_dwordx4 v[16:19], v111, s[44:47], 0 offen
    v_lshlrev_b32 v40, 5, v0
    v_add_u32 v40, 81920, v40
    v_add_u32 v41, 0x10000, v40
    s_waitcnt lgkmcnt(0)
    s_barrier
    ds_read_b128 v[80:83], v40
    ds_read_b128 v[84:87], v40 offset:16
    ds_read_b128 v[88:91], v40 offset:32768
    ds_read_b128 v[92:95], v40 offset:32784
    ds_read_b128 v[96:99], v41
    ds_read_b128 v[100:103], v41 offset:16
    s_waitcnt lgkmcnt(0)
    v_cvt_pk_bf16_f32 v24, v80, v81
    v_cvt_pk_bf16_f32 v25, v82, v83
    v_cvt_pk_bf16_f32 v26, v84, v85
    v_cvt_pk_bf16_f32 v27, v86, v87
    v_cvt_pk_bf16_f32 v28, v88, v89
    v_cvt_pk_bf16_f32 v29, v90, v91
    v_cvt_pk_bf16_f32 v30, v92, v93
    v_cvt_pk_bf16_f32 v31, v94, v95
    v_cvt_pk_bf16_f32 v32, v96, v97
    v_cvt_pk_bf16_f32 v33, v98, v99
    v_cvt_pk_bf16_f32 v34, v100, v101
    v_cvt_pk_bf16_f32 v35, v102, v103
    s_waitcnt vmcnt(0)
    v_lshlrev_b32 v88, 16, v8
    v_and_b32 v8, v6, v8
    v_lshlrev_b32 v89, 16, v9
    v_and_b32 v9, v6, v9
    v_lshlrev_b32 v90, 16, v10
    v_and_b32 v10, v6, v10
    v_lshlrev_b32 v91, 16, v11
    v_and_b32 v11, v6, v11
    v_lshlrev_b32 v112, 16, v12
    v_and_b32 v12, v6, v12
    v_lshlrev_b32 v113, 16, v13
    v_and_b32 v13, v6, v13
    v_lshlrev_b32 v114, 16, v14
    v_and_b32 v14, v6, v14
    v_lshlrev_b32 v115, 16, v15
    v_and_b32 v15, v6, v15
    v_lshlrev_b32 v44, 16, v16
    v_and_b32 v16, v6, v16
    v_lshlrev_b32 v45, 16, v17
    v_and_b32 v17, v6, v17
    v_lshlrev_b32 v46, 16, v18
    v_and_b32 v18, v6, v18
    v_lshlrev_b32 v47, 16, v19
    v_and_b32 v19, v6, v19
    s_branch K2_EPI
K2_END:
    s_endpgm
.section .rodata,"a"
.p2align 6
.amdhsa_kernel painn_pre_kernel
  .amdhsa_next_free_vgpr 128
  .amdhsa_next_free_sgpr 92
  .amdhsa_accum_offset 128
  .amdhsa_group_segment_fixed_size 0
  .amdhsa_kernarg_size 88
  .amdhsa_user_sgpr_count 2
  .amdhsa_user_sgpr_kernarg_segment_ptr 1
  .amdhsa_system_sgpr_workgroup_id_x 1
  .amdhsa_float_denorm_mode_32 3
.end_amdhsa_kernel
.p2align 6
.amdhsa_kernel painn_main_kernel
  .amdhsa_next_free_vgpr 128
  .amdhsa_next_free_sgpr 86
  .amdhsa_accum_offset 128
  .amdhsa_group_segment_fixed_size 0
  .amdhsa_kernarg_size 88
  .amdhsa_user_sgpr_count 2
  .amdhsa_user_sgpr_kernarg_segment_ptr 1
  .amdhsa_system_sgpr_workgroup_id_x 1
  .amdhsa_float_denorm_mode_32 3
.end_amdhsa_kernel
```
